```python
import torch

def _softmax(x, axis=-1):
    return torch.softmax(x, dim=axis)
def _gelu(x):
    return torch.nn.functional.gelu(x, approximate="tanh")
def _silu(x):
    return torch.nn.functional.silu(x)
def _sigmoid(x):
    return torch.sigmoid(x)
def _layernorm(x, axis=-1, eps=1e-5):
    m = x.mean(dim=axis, keepdim=True)
    v = x.var(dim=axis, keepdim=True, unbiased=False)
    return (x - m) / torch.sqrt(v + eps)
def _scatter_add(tgt, idx, src, axis=0):
    return tgt.clone().index_add_(axis, idx, src)
def _segment_sum(src, seg, n):
    out = torch.zeros((n,) + src.shape[1:], dtype=src.dtype)
    return out.index_add_(0, seg, src)
def _pad(x, pw):
    flat = tuple(v for pair in reversed(pw) for v in pair)
    return torch.nn.functional.pad(x, flat)

kernel_name = 'sequential_preLN__spectral_fnet__dense_activation_squared_relu__prompt'

def setup_inputs():

    _w = (lambda a: (lambda t: t.to(torch.bfloat16) if t.is_floating_point() else t)(torch.as_tensor(a)))
    def _A_setup():
        B, S, D = 1, 2048, 512
        ns = torch.arange(S)[:, None] * torch.arange(S)[None, :]
        nd = torch.arange(D)[:, None] * torch.arange(D)[None, :]
        Ws_re = torch.cos(-2.0 * torch.pi * ns / S).to(float)
        Ws_im = torch.sin(-2.0 * torch.pi * ns / S).to(float)
        Wd_re = torch.cos(-2.0 * torch.pi * nd / D).to(float)
        Wd_im = torch.sin(-2.0 * torch.pi * nd / D).to(float)
        return {
            "x": _w((lambda *s: torch.randn(*s, dtype=torch.bfloat16) * 0.05)(B, S, D)),
            "dft_seq_re": _w(Ws_re),
            "dft_seq_im": _w(Ws_im),
            "dft_hid_re": _w(Wd_re),
            "dft_hid_im": _w(Wd_im),
        }
    _A_in = _A_setup()

    def _B_setup():
        B, S, D, F = 1, 2048, 512, 1792
        return {
            "x": _w((lambda *s: torch.randn(*s, dtype=torch.bfloat16) * 0.05)(B, S, D)),
            "w1": _w((lambda *s: torch.randn(*s, dtype=torch.bfloat16) * 0.2)(D, F)),
            "b1": _w((lambda *s: torch.randn(*s, dtype=torch.bfloat16) * 0.2)(F)),
            "w2": _w((lambda *s: torch.randn(*s, dtype=torch.bfloat16) * 0.2)(F, D)),
            "b2": _w((lambda *s: torch.randn(*s, dtype=torch.bfloat16) * 0.2)(D)),
        }
    _B_in = _B_setup()

    return {
        "A_x": _A_in["x"],
        "A_dft_seq_re": _A_in["dft_seq_re"],
        "A_dft_seq_im": _A_in["dft_seq_im"],
        "A_dft_hid_re": _A_in["dft_hid_re"],
        "A_dft_hid_im": _A_in["dft_hid_im"],
        "B_x": _B_in["x"],
        "B_w1": _B_in["w1"],
        "B_b1": _B_in["b1"],
        "B_w2": _B_in["w2"],
        "B_b2": _B_in["b2"],
    }

def reference(A_x, A_dft_seq_re, A_dft_seq_im, A_dft_hid_re, A_dft_hid_im, B_x, B_w1, B_b1, B_w2, B_b2):
    def _A_ref(x, dft_seq_re, dft_seq_im, dft_hid_re, dft_hid_im):
        a = torch.einsum("bsd,ed->bse", x, dft_hid_re)
        b = torch.einsum("bsd,ed->bse", x, dft_hid_im)
        y = torch.einsum("ts,bse->bte", dft_seq_re, a) - torch.einsum("ts,bse->bte", dft_seq_im, b)
        return y

    def _B_ref(x, w1, b1, w2, b2):
        h = torch.einsum("bsd,df->bsf", x, w1) + b1
        zero = torch.zeros_like(h)
        r = torch.where(h > zero, h, zero)
        h = r * r
        out = torch.einsum("bsf,fd->bsd", h, w2) + b2
        return out

    x = A_x
    h = x + _A_ref(_layernorm(x, axis=-1), A_dft_seq_re, A_dft_seq_im, A_dft_hid_re, A_dft_hid_im)
    h2 = h + _B_ref(_layernorm(h, axis=-1), B_w1, B_b1, B_w2, B_b2)
    return h2
```

```asm
; @launch kernel=fnet_kernel grid=(256,1,1) block=(256,1,1) lds=163840
.amdgcn_target "amdgcn-amd-amdhsa--gfx950"
.text
.globl fnet_kernel
.p2align 8
.type fnet_kernel,@function
fnet_kernel:
    s_cmp_ge_u32 s2, 256
    s_cbranch_scc1 fnet_kernel_end
    s_load_dwordx2 s[4:5], s[0:1], 0
    s_load_dwordx16 s[48:63], s[0:1], 40
    s_getpc_b64 s[12:13]
    s_and_b32 s3, s2, 0xf8
    v_and_b32 v2, 7, v0
    v_or_b32 v2, s3, v2
    v_lshlrev_b32 v2, 7, v2
    v_min_u32 v2, code_end-fnet_kernel-68, v2
    global_load_dword v53, v2, s[12:13]
    v_lshrrev_b32 v2, 6, v0
    v_and_b32 v1, 63, v0
    v_readfirstlane_b32 s22, v2
    s_and_b32 s23, s2, 6
    s_lshl_b32 s23, s23, 1
    s_bfe_u32 s24, s2, 0x20004
    s_add_u32 s23, s23, s24
    s_sub_u32 s24, 32, s23
    s_cmp_eq_u32 s23, 0
    s_cselect_b32 s24, 16, s24
    s_bitcmp1_b32 s2, 3
    s_cselect_b32 s20, s24, s23
    s_lshr_b32 s16, s2, 6
    s_and_b32 s24, s2, 1
    s_lshl_b32 s24, s24, 2
    s_add_u32 s21, s16, s24
    s_lshl_b32 s16, s16, 19
    s_sub_u32 s23, 64, s20
    s_cmp_eq_u32 s20, 0
    s_cselect_b32 s23, 32, s23
    v_mov_b32 v4, s20
    v_mov_b32 v6, s23
    s_mov_b32 vcc_lo, 0xff00ff00
    s_mov_b32 vcc_hi, 0xff00ff00
    v_lshrrev_b32 v2, 5, v0
    v_cndmask_b32 v4, v4, v6, vcc
    v_lshl_add_u32 v4, v2, 6, v4
    v_lshlrev_b32 v4, 10, v4
    v_and_b32 v5, 7, v0
    v_lshl_add_u32 v4, v5, 7, v4
    s_mov_b32 s30, 0x200000
    s_mov_b32 s31, 0x20000
    v_lshlrev_b32 v3, 4, v1
    s_mov_b32 s34, 9437184
    s_mov_b32 s35, s31
    s_and_b32 s67, s22, 1
    s_lshr_b32 s68, s22, 1
    s_waitcnt lgkmcnt(0)
    s_mov_b32 s28, s4
    s_and_b32 s29, s5, 0xffff
    buffer_load_dword v52, v4, s[28:31], s16 offen
    s_load_dword s40, s[62:63], s30
    s_mov_b32 s32, s62
    s_and_b32 s33, s63, 0xffff
    s_lshl_b32 s24, s22, 18
    s_lshl_b32 s25, s20, 10
    s_add_u32 s25, s25, s24
    s_lshl_b32 s26, s23, 10
    s_add_u32 s26, s26, s24
    s_mul_i32 s27, s22, 4160
    v_and_b32 v4, 7, v1
    s_lshl_b32 s16, s21, 5
    s_lshl_b32 s17, s22, 3
    s_add_u32 s16, s16, s17
    v_add_u32 v4, s16, v4
    v_cmp_eq_u32 vcc, 0, v4
    v_mov_b32 v5, 0x100
    v_bfe_u32 v7, v1, 4, 1
    v_cndmask_b32 v4, v4, v5, vcc
    v_lshlrev_b32 v6, 31, v4
    v_lshrrev_b32 v5, 16, v6
    v_or_b32 v6, v6, v5
    v_cvt_f32_u32 v4, v4
    v_mul_f32 v4, 0x3b000000, v4
    v_lshlrev_b32 v7, 7, v7
    v_bfe_u32 v8, v1, 5, 1
    v_lshl_add_u32 v7, v8, 6, v7
    s_lshl_b32 s19, s67, 5
    s_lshl_b32 s17, s68, 8
    s_or_b32 s16, s19, s17
    v_or_b32 v8, s16, v7
    v_xor_b32 v9, 32, v8
    v_and_b32 v14, 15, v1
    v_mul_u32_u24 v14, 1040, v14
    v_lshl_add_u32 v10, v8, 1, v14
    v_lshl_add_u32 v11, v9, 1, v14
    v_xor_b32 v15, 0x100, v8
    v_lshl_add_u32 v12, v15, 1, v14
    v_xor_b32 v15, 0x100, v9
    v_lshl_add_u32 v13, v15, 1, v14
    v_bfe_u32 v15, v1, 3, 1
    v_cvt_f32_u32 v16, v15
    v_mul_f32 v16, 0x3e800000, v16
    v_lshlrev_b32 v17, 31, v15
    v_lshrrev_b32 v18, 16, v17
    v_or_b32 v17, v17, v18
    v_cvt_f32_u32 v8, v8
    v_cvt_f32_u32 v9, v9
    v_fma_f32 v8, v8, v4, v16
    v_fma_f32 v9, v9, v4, v16
    v_add_f32 v18, v4, v4
    v_cos_f32 v18, v18
    v_cos_f32 v20, v8
    v_add_f32 v8, v8, v4
    v_cos_f32 v24, v9
    v_add_f32 v9, v9, v4
    v_cos_f32 v21, v8
    v_add_f32 v8, v8, v4
    v_cos_f32 v25, v9
    v_add_f32 v9, v9, v4
    v_cos_f32 v22, v8
    v_add_f32 v8, v8, v4
    v_cos_f32 v26, v9
    v_add_f32 v9, v9, v4
    v_cos_f32 v23, v8
    v_cos_f32 v27, v9
    v_add_f32 v18, v18, v18
    v_mov_b32 v19, v18
    v_cvt_pk_bf16_f32 v64, v20, v21
    v_cvt_pk_bf16_f32 v80, v24, v25
    v_pk_fma_f32 v[20:21], v[18:19], v[22:23], v[20:21] neg_lo:[0,0,1] neg_hi:[0,0,1]
    v_pk_fma_f32 v[24:25], v[18:19], v[26:27], v[24:25] neg_lo:[0,0,1] neg_hi:[0,0,1]
    v_xor_b32 v96, v6, v64
    v_xor_b32 v112, v6, v80
    v_cvt_pk_bf16_f32 v65, v22, v23
    v_cvt_pk_bf16_f32 v81, v26, v27
    v_pk_fma_f32 v[22:23], v[18:19], v[20:21], v[22:23] neg_lo:[0,0,1] neg_hi:[0,0,1]
    v_pk_fma_f32 v[26:27], v[18:19], v[24:25], v[26:27] neg_lo:[0,0,1] neg_hi:[0,0,1]
    v_xor_b32 v97, v6, v65
    v_xor_b32 v113, v6, v81
    v_cvt_pk_bf16_f32 v66, v20, v21
    v_cvt_pk_bf16_f32 v82, v24, v25
    v_pk_fma_f32 v[20:21], v[18:19], v[22:23], v[20:21] neg_lo:[0,0,1] neg_hi:[0,0,1]
    v_pk_fma_f32 v[24:25], v[18:19], v[26:27], v[24:25] neg_lo:[0,0,1] neg_hi:[0,0,1]
    v_xor_b32 v98, v6, v66
    v_xor_b32 v114, v6, v82
    v_cvt_pk_bf16_f32 v67, v22, v23
    v_cvt_pk_bf16_f32 v83, v26, v27
    v_pk_fma_f32 v[22:23], v[18:19], v[20:21], v[22:23] neg_lo:[0,0,1] neg_hi:[0,0,1]
    v_pk_fma_f32 v[26:27], v[18:19], v[24:25], v[26:27] neg_lo:[0,0,1] neg_hi:[0,0,1]
    v_xor_b32 v99, v6, v67
    v_xor_b32 v115, v6, v83
    v_cvt_pk_bf16_f32 v68, v20, v21
    v_cvt_pk_bf16_f32 v84, v24, v25
    v_pk_fma_f32 v[20:21], v[18:19], v[22:23], v[20:21] neg_lo:[0,0,1] neg_hi:[0,0,1]
    v_pk_fma_f32 v[24:25], v[18:19], v[26:27], v[24:25] neg_lo:[0,0,1] neg_hi:[0,0,1]
    v_xor_b32 v100, v6, v68
    v_xor_b32 v116, v6, v84
    v_cvt_pk_bf16_f32 v69, v22, v23
    v_cvt_pk_bf16_f32 v85, v26, v27
    v_pk_fma_f32 v[22:23], v[18:19], v[20:21], v[22:23] neg_lo:[0,0,1] neg_hi:[0,0,1]
    v_pk_fma_f32 v[26:27], v[18:19], v[24:25], v[26:27] neg_lo:[0,0,1] neg_hi:[0,0,1]
    v_xor_b32 v101, v6, v69
    v_xor_b32 v117, v6, v85
    v_cvt_pk_bf16_f32 v70, v20, v21
    v_cvt_pk_bf16_f32 v86, v24, v25
    v_pk_fma_f32 v[20:21], v[18:19], v[22:23], v[20:21] neg_lo:[0,0,1] neg_hi:[0,0,1]
    v_pk_fma_f32 v[24:25], v[18:19], v[26:27], v[24:25] neg_lo:[0,0,1] neg_hi:[0,0,1]
    v_xor_b32 v102, v6, v70
    v_xor_b32 v118, v6, v86
    v_cvt_pk_bf16_f32 v71, v22, v23
    v_cvt_pk_bf16_f32 v87, v26, v27
    v_pk_fma_f32 v[22:23], v[18:19], v[20:21], v[22:23] neg_lo:[0,0,1] neg_hi:[0,0,1]
    v_pk_fma_f32 v[26:27], v[18:19], v[24:25], v[26:27] neg_lo:[0,0,1] neg_hi:[0,0,1]
    v_xor_b32 v103, v6, v71
    v_xor_b32 v119, v6, v87
    v_cvt_pk_bf16_f32 v72, v20, v21
    v_cvt_pk_bf16_f32 v88, v24, v25
    v_pk_fma_f32 v[20:21], v[18:19], v[22:23], v[20:21] neg_lo:[0,0,1] neg_hi:[0,0,1]
    v_pk_fma_f32 v[24:25], v[18:19], v[26:27], v[24:25] neg_lo:[0,0,1] neg_hi:[0,0,1]
    v_xor_b32 v104, v6, v72
    v_xor_b32 v120, v6, v88
    v_cvt_pk_bf16_f32 v73, v22, v23
    v_cvt_pk_bf16_f32 v89, v26, v27
    v_pk_fma_f32 v[22:23], v[18:19], v[20:21], v[22:23] neg_lo:[0,0,1] neg_hi:[0,0,1]
    v_pk_fma_f32 v[26:27], v[18:19], v[24:25], v[26:27] neg_lo:[0,0,1] neg_hi:[0,0,1]
    v_xor_b32 v105, v6, v73
    v_xor_b32 v121, v6, v89
    v_cvt_pk_bf16_f32 v74, v20, v21
    v_cvt_pk_bf16_f32 v90, v24, v25
    v_pk_fma_f32 v[20:21], v[18:19], v[22:23], v[20:21] neg_lo:[0,0,1] neg_hi:[0,0,1]
    v_pk_fma_f32 v[24:25], v[18:19], v[26:27], v[24:25] neg_lo:[0,0,1] neg_hi:[0,0,1]
    v_xor_b32 v106, v6, v74
    v_xor_b32 v122, v6, v90
    v_cvt_pk_bf16_f32 v75, v22, v23
    v_cvt_pk_bf16_f32 v91, v26, v27
    v_pk_fma_f32 v[22:23], v[18:19], v[20:21], v[22:23] neg_lo:[0,0,1] neg_hi:[0,0,1]
    v_pk_fma_f32 v[26:27], v[18:19], v[24:25], v[26:27] neg_lo:[0,0,1] neg_hi:[0,0,1]
    v_xor_b32 v107, v6, v75
    v_xor_b32 v123, v6, v91
    v_cvt_pk_bf16_f32 v76, v20, v21
    v_cvt_pk_bf16_f32 v92, v24, v25
    v_pk_fma_f32 v[20:21], v[18:19], v[22:23], v[20:21] neg_lo:[0,0,1] neg_hi:[0,0,1]
    v_pk_fma_f32 v[24:25], v[18:19], v[26:27], v[24:25] neg_lo:[0,0,1] neg_hi:[0,0,1]
    v_xor_b32 v108, v6, v76
    v_xor_b32 v124, v6, v92
    v_cvt_pk_bf16_f32 v77, v22, v23
    v_cvt_pk_bf16_f32 v93, v26, v27
    v_pk_fma_f32 v[22:23], v[18:19], v[20:21], v[22:23] neg_lo:[0,0,1] neg_hi:[0,0,1]
    v_pk_fma_f32 v[26:27], v[18:19], v[24:25], v[26:27] neg_lo:[0,0,1] neg_hi:[0,0,1]
    v_xor_b32 v109, v6, v77
    v_xor_b32 v125, v6, v93
    v_cvt_pk_bf16_f32 v78, v20, v21
    v_cvt_pk_bf16_f32 v94, v24, v25
    v_xor_b32 v110, v6, v78
    v_xor_b32 v126, v6, v94
    v_cvt_pk_bf16_f32 v79, v22, v23
    v_cvt_pk_bf16_f32 v95, v26, v27
    v_xor_b32 v111, v6, v79
    v_xor_b32 v127, v6, v95
    s_add_u32 m0, s27, 0
    s_add_u32 s3, s25, 0
    buffer_load_dwordx4 v3, s[28:31], s3 offen lds
    s_add_u32 m0, s27, 1040
    s_add_u32 s3, s25, 65536
    s_mul_i32 s14, s22, 20480
    s_add_u32 s14, s14, 66560
    v_and_b32 v4, 3, v1
    v_cmp_eq_u32 s[6:7], 1, v4
    v_cmp_eq_u32 s[8:9], 2, v4
    v_cmp_eq_u32 s[10:11], 3, v4
    v_bfe_u32 v6, v1, 2, 2
    v_lshrrev_b32 v5, 4, v1
    v_cmp_eq_u32 vcc, v6, v5
    v_and_b32 v7, 15, v1
    s_lshl_b32 s16, s22, 9
    s_add_u32 s16, s16, 148480
    v_lshl_add_u32 v19, v7, 3, s16
    buffer_load_dwordx4 v3, s[28:31], s3 offen lds
    s_add_u32 m0, s27, 2080
    s_add_u32 s3, s25, 131072
    v_mov_b32 v8, 151552
    v_cndmask_b32 v19, v8, v19, vcc
    v_lshl_add_u32 v16, v6, 2, v5
    v_lshl_add_u32 v16, v16, 2, v4
    s_mov_b32 s16, 148480
    v_lshl_add_u32 v16, v16, 3, s16
    s_mov_b32 s36, s50
    s_and_b32 s37, s51, 0xffff
    s_mov_b32 s38, 0x1c0000
    s_mov_b32 s39, 0x20000
    s_lshr_b32 s16, s21, 1
    s_mul_i32 s16, s16, 896
    s_and_b32 s17, s21, 1
    buffer_load_dwordx4 v3, s[28:31], s3 offen lds
    s_add_u32 m0, s27, 3120
    s_add_u32 s3, s25, 196608
    s_mul_i32 s18, s17, 640
    s_add_u32 s64, s16, s18
    s_lshl_b32 s18, s22, 6
    s_add_u32 s64, s64, s18
    s_mul_i32 s18, s17, 192
    s_add_u32 s65, s16, s18
    s_mul_i32 s18, s68, 96
    s_add_u32 s65, s65, s18
    s_add_u32 s65, s65, s19
    s_add_u32 s65, s65, 256
    s_lshr_b32 s16, s2, 3
    s_and_b32 s74, s16, 7
    s_movk_i32 s18, 3584
    buffer_load_dwordx4 v3, s[28:31], s3 offen lds
    s_add_u32 m0, s27, 16640
    s_add_u32 s3, s25, 1048576
    s_mov_b32 s75, 56320
    s_cmp_ge_u32 s74, 4
    s_cselect_b32 s16, 7, 0
    s_cselect_b32 s17, 1146880, 0
    s_cselect_b32 s18, -3584, s18
    s_cselect_b32 s75, -58368, s75
    s_xor_b32 s16, s16, s74
    s_xor_b32 s70, s16, 0
    s_mul_i32 s70, s70, 229376
    s_xor_b32 s71, s16, 1
    s_mul_i32 s71, s71, 229376
    s_xor_b32 s72, s16, 2
    s_mul_i32 s72, s72, 229376
    buffer_load_dwordx4 v3, s[28:31], s3 offen lds
    s_add_u32 m0, s27, 17680
    s_add_u32 s3, s25, 1114112
    s_xor_b32 s73, s16, 3
    s_mul_i32 s73, s73, 229376
    v_lshrrev_b32 v9, 2, v1
    v_and_b32 v8, 2, v5
    v_xor_b32 v8, v8, v4
    v_lshl_add_u32 v8, v8, 4, s17
    v_mad_i32_i24 v42, v9, s18, v8
    v_add_u32 v43, s75, v42
    v_add_u32 v44, s75, v43
    v_add_u32 v45, s75, v44
    v_add_u32 v47, 229376, v3
    v_lshl_add_u32 v8, v5, 9, s14
    v_lshl_add_u32 v8, v6, 6, v8
    buffer_load_dwordx4 v3, s[28:31], s3 offen lds
    s_add_u32 m0, s27, 18720
    s_add_u32 s3, s25, 1179648
    v_lshl_add_u32 v8, v4, 3, v8
    v_and_b32 v9, 1, v5
    v_lshl_add_u32 v40, v9, 5, v8
    v_xor_b32 v41, 32, v40
    v_and_b32 v4, 15, v1
    v_lshlrev_b32 v6, 31, v4
    v_lshrrev_b32 v7, 16, v6
    v_or_b32 v6, v6, v7
    v_lshrrev_b32 v5, 4, v1
    v_lshlrev_b32 v5, 8, v5
    s_cmp_eq_u32 s20, 0
    s_cselect_b32 s17, 0x3e800000, 0
    v_add_u32 v7, 0, v4
    buffer_load_dwordx4 v3, s[28:31], s3 offen lds
    s_add_u32 m0, s27, 19760
    s_add_u32 s3, s25, 1245184
    v_cvt_f32_u32 v7, v7
    v_mul_f32 v18, 0x3d000000, v7
    v_mul_f32 v7, 0x3a000000, v7
    v_add_u32 v8, s20, v5
    v_cvt_f32_u32 v8, v8
    v_mul_f32 v8, v8, v7
    v_cos_f32 v20, v8
    v_sin_f32 v22, v8
    v_add_f32 v8, v8, v18
    v_cos_f32 v21, v8
    buffer_load_dwordx4 v3, s[28:31], s3 offen lds
    v_sin_f32 v23, v8
    v_add_f32 v8, v8, v18
    v_cvt_pk_bf16_f32 v128, v20, v21
    v_cvt_pk_bf16_f32 v132, v22, v23
    v_xor_b32 v130, v6, v128
    v_xor_b32 v134, v6, v132
    v_cos_f32 v20, v8
    v_sin_f32 v22, v8
    v_add_f32 v8, v8, v18
    v_cos_f32 v21, v8
    v_sin_f32 v23, v8
    v_cvt_pk_bf16_f32 v129, v20, v21
    v_cvt_pk_bf16_f32 v133, v22, v23
    v_xor_b32 v131, v6, v129
    v_xor_b32 v135, v6, v133
    v_add_u32 v8, s23, v5
    v_cvt_f32_u32 v8, v8
    v_fma_f32 v8, v8, v7, s17
    v_cos_f32 v20, v8
    v_sin_f32 v22, v8
    v_add_f32 v8, v8, v18
    v_cos_f32 v21, v8
    v_sin_f32 v23, v8
    v_add_f32 v8, v8, v18
    v_cvt_pk_bf16_f32 v144, v20, v21
    v_cvt_pk_bf16_f32 v148, v22, v23
    v_xor_b32 v146, v6, v144
    v_xor_b32 v150, v6, v148
    v_cos_f32 v20, v8
    v_sin_f32 v22, v8
    v_add_f32 v8, v8, v18
    v_cos_f32 v21, v8
    v_sin_f32 v23, v8
    v_cvt_pk_bf16_f32 v145, v20, v21
    v_cvt_pk_bf16_f32 v149, v22, v23
    v_xor_b32 v147, v6, v145
    v_xor_b32 v151, v6, v149
    v_add_u32 v7, 16, v4
    v_cvt_f32_u32 v7, v7
    v_mul_f32 v18, 0x3d000000, v7
    v_mul_f32 v7, 0x3a000000, v7
    s_add_u32 m0, s27, 33280
    s_add_u32 s3, s26, 0
    buffer_load_dwordx4 v3, s[28:31], s3 offen lds
    s_add_u32 m0, s27, 34320
    s_add_u32 s3, s26, 65536
    v_add_u32 v8, s20, v5
    v_cvt_f32_u32 v8, v8
    v_mul_f32 v8, v8, v7
    v_cos_f32 v20, v8
    v_sin_f32 v22, v8
    v_add_f32 v8, v8, v18
    v_cos_f32 v21, v8
    v_sin_f32 v23, v8
    v_add_f32 v8, v8, v18
    buffer_load_dwordx4 v3, s[28:31], s3 offen lds
    s_add_u32 m0, s27, 35360
    s_add_u32 s3, s26, 131072
    v_cvt_pk_bf16_f32 v136, v20, v21
    v_cvt_pk_bf16_f32 v140, v22, v23
    v_xor_b32 v138, v6, v136
    v_xor_b32 v142, v6, v140
    v_cos_f32 v20, v8
    v_sin_f32 v22, v8
    v_add_f32 v8, v8, v18
    v_cos_f32 v21, v8
    v_sin_f32 v23, v8
    v_cvt_pk_bf16_f32 v137, v20, v21
    v_cvt_pk_bf16_f32 v141, v22, v23
    v_xor_b32 v139, v6, v137
    v_xor_b32 v143, v6, v141
    v_add_u32 v8, s23, v5
    v_cvt_f32_u32 v8, v8
    v_fma_f32 v8, v8, v7, s17
    v_cos_f32 v20, v8
    v_sin_f32 v22, v8
    v_add_f32 v8, v8, v18
    v_cos_f32 v21, v8
    v_sin_f32 v23, v8
    v_add_f32 v8, v8, v18
    v_cvt_pk_bf16_f32 v152, v20, v21
    v_cvt_pk_bf16_f32 v156, v22, v23
    v_xor_b32 v154, v6, v152
    v_xor_b32 v158, v6, v156
    v_cos_f32 v20, v8
    v_sin_f32 v22, v8
    v_add_f32 v8, v8, v18
    v_cos_f32 v21, v8
    v_sin_f32 v23, v8
    v_cvt_pk_bf16_f32 v153, v20, v21
    v_cvt_pk_bf16_f32 v157, v22, v23
    v_xor_b32 v155, v6, v153
    v_xor_b32 v159, v6, v157
    v_mov_b32 v56, 0x3f803f80
    v_mov_b32 v57, 0x3f803f80
    v_mov_b32 v58, 0x3f803f80
    v_mov_b32 v59, 0x3f803f80
    v_ashrrev_i32 v60, 31, v6
    v_and_b32 v60, 0xaaaaaaaa, v60
    v_or_b32 v60, 0x44444444, v60
    v_mov_b64 v[228:229], 0
    v_mov_b64 v[236:237], 0
    v_mov_b64 v[244:245], 0
    v_mov_b64 v[252:253], 0
    v_ashrrev_i32 v21, 31, v17
    v_not_b32 v20, v21
    s_cmp_lg_u32 s20, 0
    s_cselect_b32 s16, -1, 0
    v_or_b32 v20, s16, v20
    v_or_b32 v21, s16, v21
    buffer_load_dwordx4 v3, s[28:31], s3 offen lds
    s_add_u32 m0, s27, 36400
    s_add_u32 s3, s26, 196608
    buffer_load_dwordx4 v3, s[28:31], s3 offen lds
    s_add_u32 m0, s27, 49920
    s_add_u32 s3, s26, 1048576
    buffer_load_dwordx4 v3, s[28:31], s3 offen lds
    s_add_u32 m0, s27, 50960
    s_add_u32 s3, s26, 1114112
    buffer_load_dwordx4 v3, s[28:31], s3 offen lds
    s_add_u32 m0, s27, 52000
    s_add_u32 s3, s26, 1179648
    buffer_load_dwordx4 v3, s[28:31], s3 offen lds
    s_add_u32 m0, s27, 53040
    s_add_u32 s3, s26, 1245184
    buffer_load_dwordx4 v3, s[28:31], s3 offen lds
    s_waitcnt lgkmcnt(0)
    s_mov_b32 s48, 0x40004000
    s_andn2_b32 s40, 0x80000000, s40
    s_cselect_b32 s42, s48, 0
    s_xor_b32 s43, s42, s48
    s_pack_lh_b32_b16 s41, s42, s43
    s_waitcnt vmcnt(12)
    s_barrier
    ds_read_b128 v[160:163], v10 offset:0
    ds_read_b128 v[164:167], v10 offset:16
    s_add_u32 m0, s14, 0
    s_add_u32 s3, s70, s64
    s_cmp_eq_u32 s74, 4
    s_cselect_b64 s[0:1], 15, 0
    ds_read_b128 v[168:171], v10 offset:32
    ds_read_b128 v[172:175], v10 offset:48
    ds_read_b128 v[176:179], v11 offset:0
    ds_read_b128 v[180:183], v11 offset:16
    ds_read_b128 v[184:187], v11 offset:32
    ds_read_b128 v[188:191], v11 offset:48
    s_waitcnt lgkmcnt(7)
    v_mfma_f32_16x16x32_bf16 v[208:211], v[160:163], v[64:67], 0
    ds_read_b128 v[192:195], v12 offset:0
    v_mfma_f32_16x16x32_bf16 v[224:227], v[160:163], v[160:163], 0
    buffer_load_dwordx4 v43, s[36:39], s3 offen offset:1024 lds
    s_waitcnt lgkmcnt(7)
    v_mfma_f32_16x16x32_bf16 v[208:211], v[164:167], v[68:71], v[208:211]
    ds_read_b128 v[196:199], v12 offset:16
    ds_read_b128 v[200:203], v12 offset:32
    v_mfma_f32_16x16x32_bf16 v[224:227], v[164:167], v[164:167], v[224:227]
    v_cndmask_b32 v46, v42, v47, s[0:1]
    v_smfmac_f32_16x16x64_bf16 v[228:231], v[56:59], v[160:167], v60
    s_waitcnt lgkmcnt(8)
    ds_read_b128 v[204:207], v12 offset:48
    v_mfma_f32_16x16x32_bf16 v[208:211], v[168:171], v[72:75], v[208:211]
    ds_read_b128 v[160:163], v13 offset:0
    buffer_load_dwordx4 v44, s[36:39], s3 offen offset:2048 lds
    v_mfma_f32_16x16x32_bf16 v[224:227], v[168:171], v[168:171], v[224:227]
    s_mul_i32 s18, s21, 448
    s_lshl_b32 s17, s21, 7
    s_cmp_eq_u32 s67, 0
    s_cselect_b64 s[12:13], s[52:53], s[56:57]
    s_cselect_b32 s18, s18, s17
    s_cselect_b32 s17, 6, 0
    v_min_u32 v62, s17, v1
    v_lshl_add_u32 v62, v62, 6, s18
    s_waitcnt lgkmcnt(8)
    v_mfma_f32_16x16x32_bf16 v[208:211], v[172:175], v[76:79], v[208:211]
    ds_read_b128 v[164:167], v13 offset:16
    v_mfma_f32_16x16x32_bf16 v[224:227], v[172:175], v[172:175], v[224:227]
    buffer_load_dwordx4 v45, s[36:39], s3 offen offset:3072 lds
    v_smfmac_f32_16x16x64_bf16 v[228:231], v[56:59], v[168:175], v60
    ds_read_b128 v[168:171], v13 offset:32
    ds_read_b128 v[172:175], v13 offset:48
    v_mfma_f32_16x16x32_bf16 v[208:211], v[176:179], v[80:83], v[208:211]
    s_waitcnt vmcnt(11)
    s_barrier
    s_waitcnt lgkmcnt(5)
    v_mfma_f32_16x16x32_bf16 v[208:211], v[180:183], v[84:87], v[208:211]
    ds_read_b128 v[176:179], v10 offset:16640
    buffer_load_dwordx4 v46, s[36:39], s3 offen offset:0 lds
    v_mfma_f32_16x16x32_bf16 v[208:211], v[184:187], v[88:91], v[208:211]
    s_add_u32 m0, s14, 4096
    ds_read_b128 v[180:183], v10 offset:16656
    v_cndmask_b32 v24, v224, v225, s[6:7]
    v_mfma_f32_16x16x32_bf16 v[208:211], v[188:191], v[92:95], v[208:211]
    s_add_u32 s3, s70, s65
    ds_read_b128 v[184:187], v10 offset:16672
    v_cndmask_b32 v24, v24, v226, s[8:9]
    v_mfma_f32_16x16x32_bf16 v[208:211], v[192:195], v[96:99], v[208:211]
    s_cmp_eq_u32 s74, 4
    s_cselect_b64 s[0:1], 15, 0
    ds_read_b128 v[188:191], v10 offset:16688
    v_mfma_f32_16x16x32_bf16 v[208:211], v[196:199], v[100:103], v[208:211]
    ds_read_b128 v[192:195], v11 offset:16640
    buffer_load_dwordx4 v43, s[36:39], s3 offen offset:1024 lds
    v_mfma_f32_16x16x32_bf16 v[208:211], v[200:203], v[104:107], v[208:211]
    s_waitcnt lgkmcnt(7)
    ds_read_b128 v[196:199], v11 offset:16656
    v_cndmask_b32 v46, v42, v47, s[0:1]
    v_mfma_f32_16x16x32_bf16 v[208:211], v[204:207], v[108:111], v[208:211]
    ds_read_b128 v[200:203], v11 offset:16672
    v_cndmask_b32 v24, v24, v227, s[10:11]
    v_mfma_f32_16x16x32_bf16 v[208:211], v[160:163], v[112:115], v[208:211]
    v_add_f32 v25, v228, v229
    v_mfma_f32_16x16x32_bf16 v[208:211], v[164:167], v[116:119], v[208:211]
    s_waitcnt lgkmcnt(7)
    ds_write_b64 v19, v[24:25] offset:0
    v_mfma_f32_16x16x32_bf16 v[208:211], v[168:171], v[120:123], v[208:211]
    ds_read_b128 v[204:207], v11 offset:16688
    buffer_load_dwordx4 v44, s[36:39], s3 offen offset:2048 lds
    v_mfma_f32_16x16x32_bf16 v[208:211], v[172:175], v[124:127], v[208:211]
    s_waitcnt lgkmcnt(8)
    ds_read_b128 v[160:163], v12 offset:16640
    v_and_b32 v4, 15, v1
    v_mfma_f32_16x16x32_bf16 v[212:215], v[176:179], v[64:67], 0
    ds_read_b128 v[164:167], v12 offset:16656
    v_lshrrev_b32 v5, 5, v1
    v_mfma_f32_16x16x32_bf16 v[232:235], v[176:179], v[176:179], 0
    s_waitcnt lgkmcnt(9)
    ds_read_b128 v[168:171], v12 offset:16672
    v_lshrrev_b32 v6, 4, v0
    v_mfma_f32_16x16x32_bf16 v[212:215], v[180:183], v[68:71], v[212:215]
    ds_read_b128 v[172:175], v12 offset:16688
    v_mfma_f32_16x16x32_bf16 v[232:235], v[180:183], v[180:183], v[232:235]
    buffer_load_dwordx4 v45, s[36:39], s3 offen offset:3072 lds
    v_smfmac_f32_16x16x64_bf16 v[236:239], v[56:59], v[176:183], v60
    s_waitcnt lgkmcnt(9)
    ds_read_b128 v[176:179], v13 offset:16640
    v_lshl_add_u32 v4, v5, 4, v4
    v_mfma_f32_16x16x32_bf16 v[212:215], v[184:187], v[72:75], v[212:215]
    ds_read_b128 v[180:183], v13 offset:16656
    v_lshrrev_b32 v5, 5, v0
    v_mfma_f32_16x16x32_bf16 v[232:235], v[184:187], v[184:187], v[232:235]
    v_bfi_b32 v6, 1, v6, v5
    v_xor_b32 v6, v6, v4
    v_mfma_f32_16x16x32_bf16 v[212:215], v[188:191], v[76:79], v[212:215]
    buffer_load_dwordx4 v46, s[36:39], s3 offen offset:0 lds
    v_mfma_f32_16x16x32_bf16 v[232:235], v[188:191], v[188:191], v[232:235]
    v_and_b32 v6, 7, v6
    v_lshlrev_b32 v4, 7, v4
    v_smfmac_f32_16x16x64_bf16 v[236:239], v[56:59], v[184:191], v60
    s_waitcnt lgkmcnt(7)
    ds_read_b128 v[184:187], v13 offset:16672
    ds_read_b128 v[188:191], v13 offset:16688
    v_mfma_f32_16x16x32_bf16 v[212:215], v[192:195], v[80:83], v[212:215]
    v_lshl_add_u32 v6, v6, 4, v4
    v_lshrrev_b32 v4, 3, v0
    v_mfma_f32_16x16x32_bf16 v[212:215], v[196:199], v[84:87], v[212:215]
    global_load_dword v62, v62, s[12:13]
    v_mfma_f32_16x16x32_bf16 v[212:215], v[200:203], v[88:91], v[212:215]
    s_waitcnt lgkmcnt(6)
    v_add_u32 v6, 151552, v6
    v_xor_b32 v5, v4, v0
    v_mfma_f32_16x16x32_bf16 v[212:215], v[204:207], v[92:95], v[212:215]
    v_and_b32 v5, 7, v5
    v_lshlrev_b32 v4, 15, v4
    v_mfma_f32_16x16x32_bf16 v[212:215], v[160:163], v[96:99], v[212:215]
    v_lshl_add_u32 v4, v5, 4, v4
    v_lshlrev_b32 v7, 4, v0
    v_mfma_f32_16x16x32_bf16 v[212:215], v[164:167], v[100:103], v[212:215]
    s_waitcnt vmcnt(9)
    s_barrier
    s_waitcnt lgkmcnt(2)
    v_mfma_f32_16x16x32_bf16 v[212:215], v[168:171], v[104:107], v[212:215]
    ds_read_b128 v[192:195], v10 offset:33280
    ds_read_b128 v[196:199], v10 offset:33296
    v_mfma_f32_16x16x32_bf16 v[212:215], v[172:175], v[108:111], v[212:215]
    v_add_u32 v7, 151552, v7
    v_mov_b32 v8, 0x3727c5ac
    v_mfma_f32_16x16x32_bf16 v[212:215], v[176:179], v[112:115], v[212:215]
    s_mov_b32 s16, 0x3b000000
    ds_read_b128 v[200:203], v10 offset:33312
    v_cndmask_b32 v26, v232, v233, s[6:7]
    v_mfma_f32_16x16x32_bf16 v[212:215], v[180:183], v[116:119], v[212:215]
    s_waitcnt lgkmcnt(3)
    ds_read_b128 v[204:207], v10 offset:33328
    v_cndmask_b32 v26, v26, v234, s[8:9]
    v_mfma_f32_16x16x32_bf16 v[212:215], v[184:187], v[120:123], v[212:215]
    ds_read_b128 v[160:163], v10 offset:49920
    v_cndmask_b32 v26, v26, v235, s[10:11]
    v_mfma_f32_16x16x32_bf16 v[212:215], v[188:191], v[124:127], v[212:215]
    ds_read_b128 v[164:167], v10 offset:49936
    v_add_f32 v27, v236, v237
    ds_read_b128 v[168:171], v10 offset:49952
    s_waitcnt lgkmcnt(6)
    v_mfma_f32_16x16x32_bf16 v[240:243], v[192:195], v[192:195], 0
    ds_read_b128 v[172:175], v10 offset:49968
    s_waitcnt lgkmcnt(6)
    v_mfma_f32_16x16x32_bf16 v[240:243], v[196:199], v[196:199], v[240:243]
    ds_write_b64 v19, v[26:27] offset:128
    v_smfmac_f32_16x16x64_bf16 v[244:247], v[56:59], v[192:199], v60
    s_waitcnt lgkmcnt(6)
    ds_read_b128 v[176:179], v11 offset:33280
    v_mfma_f32_16x16x32_bf16 v[240:243], v[200:203], v[200:203], v[240:243]
    s_waitcnt lgkmcnt(6)
    ds_read_b128 v[180:183], v11 offset:33296
    v_mfma_f32_16x16x32_bf16 v[240:243], v[204:207], v[204:207], v[240:243]
    ds_read_b128 v[184:187], v11 offset:33312
    v_smfmac_f32_16x16x64_bf16 v[244:247], v[56:59], v[200:207], v60
    s_waitcnt lgkmcnt(7)
    ds_read_b128 v[188:191], v11 offset:33328
    v_mfma_f32_16x16x32_bf16 v[248:251], v[160:163], v[160:163], 0
    s_waitcnt lgkmcnt(7)
    v_mfma_f32_16x16x32_bf16 v[248:251], v[164:167], v[164:167], v[248:251]
    s_nop 0
    v_cndmask_b32 v24, v240, v241, s[6:7]
    v_cndmask_b32 v24, v24, v242, s[8:9]
    v_smfmac_f32_16x16x64_bf16 v[252:255], v[56:59], v[160:167], v60
    s_waitcnt lgkmcnt(6)
    v_cndmask_b32 v24, v24, v243, s[10:11]
    v_mfma_f32_16x16x32_bf16 v[248:251], v[168:171], v[168:171], v[248:251]
    s_waitcnt lgkmcnt(5)
    v_add_f32 v25, v244, v245
    v_mfma_f32_16x16x32_bf16 v[248:251], v[172:175], v[172:175], v[248:251]
    ds_write_b64 v19, v[24:25] offset:256
    v_smfmac_f32_16x16x64_bf16 v[252:255], v[56:59], v[168:175], v60
    v_mfma_f32_16x16x32_bf16 v[216:219], v[192:195], v[64:67], 0
    ds_read_b128 v[192:195], v12 offset:33280
    v_mfma_f32_16x16x32_bf16 v[216:219], v[196:199], v[68:71], v[216:219]
    ds_read_b128 v[196:199], v12 offset:33296
    v_mfma_f32_16x16x32_bf16 v[216:219], v[200:203], v[72:75], v[216:219]
    ds_read_b128 v[200:203], v12 offset:33312
    v_cndmask_b32 v26, v248, v249, s[6:7]
    v_mfma_f32_16x16x32_bf16 v[216:219], v[204:207], v[76:79], v[216:219]
    ds_read_b128 v[204:207], v12 offset:33328
    v_cndmask_b32 v26, v26, v250, s[8:9]
    v_mfma_f32_16x16x32_bf16 v[220:223], v[160:163], v[64:67], 0
    ds_read_b128 v[160:163], v13 offset:33280
    v_cndmask_b32 v26, v26, v251, s[10:11]
    v_mfma_f32_16x16x32_bf16 v[220:223], v[164:167], v[68:71], v[220:223]
    ds_read_b128 v[164:167], v13 offset:33296
    v_add_f32 v27, v252, v253
    v_mfma_f32_16x16x32_bf16 v[220:223], v[168:171], v[72:75], v[220:223]
    ds_write_b64 v19, v[26:27] offset:384
    v_mfma_f32_16x16x32_bf16 v[220:223], v[172:175], v[76:79], v[220:223]
    s_waitcnt lgkmcnt(8)
    v_mfma_f32_16x16x32_bf16 v[216:219], v[176:179], v[80:83], v[216:219]
    ds_read_b128 v[168:171], v13 offset:33312
    v_mfma_f32_16x16x32_bf16 v[216:219], v[180:183], v[84:87], v[216:219]
    ds_read_b128 v[172:175], v13 offset:33328
    v_mfma_f32_16x16x32_bf16 v[216:219], v[184:187], v[88:91], v[216:219]
    ds_read_b128 v[176:179], v11 offset:49920
    v_mfma_f32_16x16x32_bf16 v[216:219], v[188:191], v[92:95], v[216:219]
    s_waitcnt lgkmcnt(9)
    ds_read_b128 v[180:183], v11 offset:49936
    v_mfma_f32_16x16x32_bf16 v[216:219], v[192:195], v[96:99], v[216:219]
    ds_read_b128 v[184:187], v11 offset:49952
    ds_read_b128 v[188:191], v11 offset:49968
    s_waitcnt lgkmcnt(6)
    s_barrier
    v_mfma_f32_16x16x32_bf16 v[216:219], v[196:199], v[100:103], v[216:219]
    ds_read_b64 v[24:25], v16 offset:0
    ds_read_b64 v[26:27], v16 offset:512
    v_mfma_f32_16x16x32_bf16 v[216:219], v[200:203], v[104:107], v[216:219]
    ds_read_b64 v[28:29], v16 offset:1024
    ds_read_b64 v[30:31], v16 offset:1536
    v_mfma_f32_16x16x32_bf16 v[216:219], v[204:207], v[108:111], v[216:219]
    ds_read_b128 v[192:195], v12 offset:49920
    v_mfma_f32_16x16x32_bf16 v[216:219], v[160:163], v[112:115], v[216:219]
    ds_read_b128 v[196:199], v12 offset:49936
    v_mfma_f32_16x16x32_bf16 v[216:219], v[164:167], v[116:119], v[216:219]
    s_waitcnt lgkmcnt(10)
    ds_read_b128 v[200:203], v12 offset:49952
    v_mfma_f32_16x16x32_bf16 v[216:219], v[168:171], v[120:123], v[216:219]
    ds_read_b128 v[204:207], v12 offset:49968
    v_mfma_f32_16x16x32_bf16 v[216:219], v[172:175], v[124:127], v[216:219]
    s_waitcnt lgkmcnt(10)
    ds_read_b128 v[160:163], v13 offset:49920
    v_mfma_f32_16x16x32_bf16 v[220:223], v[176:179], v[80:83], v[220:223]
    ds_read_b128 v[164:167], v13 offset:49936
    v_mfma_f32_16x16x32_bf16 v[220:223], v[180:183], v[84:87], v[220:223]
    s_waitcnt lgkmcnt(10)
    ds_read_b128 v[168:171], v13 offset:49952
    v_mfma_f32_16x16x32_bf16 v[220:223], v[184:187], v[88:91], v[220:223]
    s_waitcnt lgkmcnt(7)
    v_pk_add_f32 v[24:25], v[24:25], v[26:27]
    v_pk_add_f32 v[28:29], v[28:29], v[30:31]
    v_mfma_f32_16x16x32_bf16 v[220:223], v[188:191], v[92:95], v[220:223]
    s_waitcnt lgkmcnt(6)
    ds_read_b128 v[172:175], v13 offset:49968
    v_add_f32 v26, v25, v29
    v_mfma_f32_16x16x32_bf16 v[220:223], v[192:195], v[96:99], v[220:223]
    s_waitcnt lgkmcnt(6)
    v_add_f32 v27, v24, v28
    v_mov_b32 v24, v29
    v_mfma_f32_16x16x32_bf16 v[220:223], v[196:199], v[100:103], v[220:223]
    s_waitcnt lgkmcnt(5)
    v_mul_f32 v26, s16, v26
    v_fma_f32 v27, v27, s16, v8
    v_mfma_f32_16x16x32_bf16 v[220:223], v[200:203], v[104:107], v[220:223]
    s_waitcnt lgkmcnt(4)
    v_fma_f32 v27, -v26, v26, v27
    v_max_f32 v27, v27, v8
    v_mfma_f32_16x16x32_bf16 v[220:223], v[204:207], v[108:111], v[220:223]
    s_waitcnt lgkmcnt(3)
    v_mfma_f32_16x16x32_bf16 v[220:223], v[160:163], v[112:115], v[220:223]
    s_waitcnt lgkmcnt(2)
    v_rsq_f32 v27, v27
    v_mfma_f32_16x16x32_bf16 v[220:223], v[164:167], v[116:119], v[220:223]
    s_waitcnt lgkmcnt(1)
    v_mul_f32 v27, 0x1f800000, v27
    v_mfma_f32_16x16x32_bf16 v[220:223], v[168:171], v[120:123], v[220:223]
    s_waitcnt lgkmcnt(0)
    v_mfma_f32_16x16x32_bf16 v[220:223], v[172:175], v[124:127], v[220:223]
    ds_write_b64 v16, v[24:25] offset:7168
    v_mul_f32_dpp v208, v27, v208 row_newbcast:0 row_mask:0xf bank_mask:0xf
    v_mul_f32_dpp v209, v27, v209 row_newbcast:1 row_mask:0xf bank_mask:0xf
    v_mul_f32_dpp v210, v27, v210 row_newbcast:2 row_mask:0xf bank_mask:0xf
    v_mul_f32_dpp v211, v27, v211 row_newbcast:3 row_mask:0xf bank_mask:0xf
    v_cvt_pk_bf16_f32 v224, v208, v209
    v_cvt_pk_bf16_f32 v225, v210, v211
    v_mul_f32_dpp v212, v27, v212 row_newbcast:4 row_mask:0xf bank_mask:0xf
    v_mul_f32_dpp v213, v27, v213 row_newbcast:5 row_mask:0xf bank_mask:0xf
    v_mul_f32_dpp v214, v27, v214 row_newbcast:6 row_mask:0xf bank_mask:0xf
    v_mul_f32_dpp v215, v27, v215 row_newbcast:7 row_mask:0xf bank_mask:0xf
    v_cvt_pk_bf16_f32 v226, v212, v213
    v_cvt_pk_bf16_f32 v227, v214, v215
    v_xor_b32_dpp v232, v224, v17 row_ror:8 row_mask:0xf bank_mask:0xf
    v_xor_b32_dpp v233, v225, v17 row_ror:8 row_mask:0xf bank_mask:0xf
    v_xor_b32_dpp v234, v226, v17 row_ror:8 row_mask:0xf bank_mask:0xf
    v_xor_b32_dpp v235, v227, v17 row_ror:8 row_mask:0xf bank_mask:0xf
    v_and_b32 v224, v20, v224
    v_and_b32 v225, v20, v225
    v_and_b32 v226, v20, v226
    v_and_b32 v227, v20, v227
    v_and_b32 v232, v20, v232
    v_and_b32 v233, v20, v233
    v_and_b32 v234, v20, v234
    v_and_b32 v235, v20, v235
    v_mul_f32_dpp v216, v27, v216 row_newbcast:8 row_mask:0xf bank_mask:0xf
    v_mfma_f32_16x16x32_bf16 v[240:243], v[224:227], v[128:131], 0
    v_mul_f32_dpp v217, v27, v217 row_newbcast:9 row_mask:0xf bank_mask:0xf
    v_mul_f32_dpp v218, v27, v218 row_newbcast:10 row_mask:0xf bank_mask:0xf
    v_mfma_f32_16x16x32_bf16 v[244:247], v[224:227], v[136:139], 0
    v_mul_f32_dpp v219, v27, v219 row_newbcast:11 row_mask:0xf bank_mask:0xf
    v_cvt_pk_bf16_f32 v228, v216, v217
    v_mfma_f32_16x16x32_bf16 v[240:243], v[232:235], v[132:135], v[240:243]
    v_cvt_pk_bf16_f32 v229, v218, v219
    v_and_b32_dpp v236, v228, v21 row_ror:8 row_mask:0xf bank_mask:0xf
    v_mfma_f32_16x16x32_bf16 v[244:247], v[232:235], v[140:143], v[244:247]
    v_and_b32_dpp v237, v229, v21 row_ror:8 row_mask:0xf bank_mask:0xf
    v_bitop3_b32 v228, v228, v17, v21 bitop3:0x28
    v_bitop3_b32 v229, v229, v17, v21 bitop3:0x28
    v_mul_f32_dpp v220, v27, v220 row_newbcast:12 row_mask:0xf bank_mask:0xf
    v_mul_f32_dpp v221, v27, v221 row_newbcast:13 row_mask:0xf bank_mask:0xf
    v_mul_f32_dpp v222, v27, v222 row_newbcast:14 row_mask:0xf bank_mask:0xf
    v_mul_f32_dpp v223, v27, v223 row_newbcast:15 row_mask:0xf bank_mask:0xf
    v_cvt_pk_bf16_f32 v230, v220, v221
    v_cvt_pk_bf16_f32 v231, v222, v223
    s_nop 0
    v_and_b32_dpp v238, v230, v21 row_ror:8 row_mask:0xf bank_mask:0xf
    v_and_b32_dpp v239, v231, v21 row_ror:8 row_mask:0xf bank_mask:0xf
    v_bitop3_b32 v230, v230, v17, v21 bitop3:0x28
    v_bitop3_b32 v231, v231, v17, v21 bitop3:0x28
    s_nop 1
    v_mfma_f32_16x16x32_bf16 v[240:243], v[228:231], v[144:147], v[240:243]
    v_mfma_f32_16x16x32_bf16 v[244:247], v[228:231], v[152:155], v[244:247]
    v_mfma_f32_16x16x32_bf16 v[240:243], v[236:239], v[148:151], v[240:243]
    v_mfma_f32_16x16x32_bf16 v[244:247], v[236:239], v[156:159], v[244:247]
    s_lshl_b32 s4, s21, 12
    s_lshl_b32 s17, s20, 7
    s_add_u32 s4, s4, s17
    v_and_b32 v5, 31, v1
    v_lshrrev_b32 v2, 5, v1
    v_add_u32 v12, s19, v5
    v_sub_u32 v13, 63, v12
    v_sub_u32 v14, 32, v5
    v_and_b32 v14, 31, v14
    v_sub_u32 v15, 63, v5
    v_cvt_pk_bf16_f32 v24, v240, v241
    v_cvt_pk_bf16_f32 v25, v242, v243
    v_cvt_pk_bf16_f32 v26, v244, v245
    v_cvt_pk_bf16_f32 v27, v246, v247
    s_nop 0
    v_permlane32_swap_b32 v24, v26
    v_permlane32_swap_b32 v25, v27
    v_or_b32 v24, s42, v24
    v_or_b32 v26, s43, v26
    v_or_b32 v25, s42, v25
    v_or_b32 v27, s43, v27
    ds_write_b128 v6, v[24:27]
    s_waitcnt lgkmcnt(0)
    s_barrier
    ds_read_b128 v[24:27], v7
    s_cmp_eq_u32 s67, 0
    s_cselect_b64 vcc, -1, 0
    v_cndmask_b32 v14, v15, v14, vcc
    s_cmp_eq_u32 s20, 0
    s_cselect_b64 vcc, -1, 0
    v_cndmask_b32 v13, v13, v14, vcc
    v_mul_u32_u24 v10, 1040, v12
    v_mul_u32_u24 v11, 1040, v13
    s_lshl_b32 s17, s68, 8
    s_and_b32 s5, s74, 1
    s_lshl_b32 s18, s5, 7
    s_add_u32 s17, s17, s18
    v_lshl_add_u32 v14, v2, 4, s17
    v_xor_b32 v15, 0x80, v14
    v_add_u32 v20, v10, v14
    v_add_u32 v21, v10, v15
    v_add_u32 v9, 912, v11
    v_sub_u32 v18, v9, v14
    v_sub_u32 v19, v9, v15
    s_waitcnt lgkmcnt(0)
    buffer_store_dwordx4 v[24:27], v4, s[32:35], s4 offen sc1
    s_add_u32 m0, s14, 8192
    s_add_u32 s3, s71, s64
    s_cmp_eq_u32 s74, 5
    s_cselect_b64 s[0:1], 15, 0
    buffer_load_dwordx4 v43, s[36:39], s3 offen offset:1024 lds
    v_cndmask_b32 v46, v42, v47, s[0:1]
    s_and_b32 s24, s23, 31
    ds_read_u16 v4, v11 offset:512
    ds_read_b128 v[68:71], v20 offset:0
    ds_read_b128 v[76:79], v20 offset:32
    s_cmp_eq_u32 s67, 0
    s_cselect_b32 s24, s20, s24
    s_lshl_b32 s24, s24, 15
    ds_read_b128 v[84:87], v20 offset:64
    s_lshl_b32 s27, s68, 14
    s_add_u32 s24, s24, s27
    s_lshl_b32 s27, s5, 13
    ds_read_b128 v[92:95], v20 offset:96
    s_add_u32 s24, s24, s27
    s_xor_b32 s27, s24, 0x2000
    s_lshr_b32 s25, s74, 1
    buffer_load_dwordx4 v44, s[36:39], s3 offen offset:2048 lds
    ds_read_b128 v[100:103], v21 offset:0
    s_xor_b32 s25, s25, s68
    s_lshl_b32 s25, s25, 13
    s_lshl_b32 s26, s67, 15
    ds_read_b128 v[108:111], v21 offset:32
    s_add_u32 s25, s25, s26
    s_cmp_eq_u32 s20, 0
    s_cselect_b32 s26, 0, 0x8000
    ds_read_b128 v[116:119], v21 offset:64
    s_xor_b32 s26, s26, s25
    s_xor_b32 s26, s26, 0x4000
    s_mov_b32 s28, s54
    ds_read_b128 v[124:127], v21 offset:96
    v_and_b32 v8, 0x30, v42
    v_lshlrev_b32 v8, 1, v8
    s_and_b32 s29, s55, 0xffff
    s_mov_b32 s30, 1835008
    s_lshl_b32 s18, s21, 7
    buffer_load_dwordx4 v45, s[36:39], s3 offen offset:3072 lds
    v_add_u32 v8, 1146880, v8
    v_sub_u32 v48, v8, v42
    s_sub_u32 s75, -2048, s75
    v_add_u32 v49, s75, v48
    v_add_u32 v50, s75, v49
    v_add_u32 v51, s75, v50
    s_mov_b32 s6, -1
    s_mov_b32 s7, 0
    v_cndmask_b32 v16, v13, v12, s[6:7]
    v_cndmask_b32 v17, v12, v13, s[6:7]
    s_mov_b32 s16, 155648
    v_lshl_add_u32 v8, v17, 3, s16
    v_lshl_add_u32 v17, v16, 3, s16
    s_lshl_b32 s13, s22, 15
    s_add_u32 s13, s13, s18
    s_lshl_b32 s12, s64, 9
    buffer_load_dwordx4 v46, s[36:39], s3 offen offset:0 lds
    s_add_u32 m0, s14, 12288
    s_add_u32 s3, s72, s64
    s_cmp_eq_u32 s74, 6
    s_cselect_b64 s[0:1], 15, 0
    s_waitcnt lgkmcnt(4)
    ds_write_b32 v11, v4 offset:1024
    ds_read_b32 v25, v17
    ds_read_b32 v26, v8 offset:4
    s_mov_b32 s16, 0x00003f80
    s_mov_b32 s17, 0x3f800000
    ds_read_b128 v[132:135], v18 offset:96
    s_add_u32 s12, s12, s18
    s_mul_i32 s15, s22, 458752
    buffer_load_dwordx4 v43, s[36:39], s3 offen offset:1024 lds
    v_cndmask_b32 v46, v42, v47, s[0:1]
    s_add_u32 s15, s15, s18
    s_mov_b32 s44, 0x80008000
    ds_read_b32 v208, v18 offset:112
    v_lshlrev_b32 v64, 16, v68
    v_and_b32 v65, 0xffff0000, v68
    v_lshlrev_b32 v66, 16, v69
    v_and_b32 v67, 0xffff0000, v69
    v_lshlrev_b32 v68, 16, v70
    v_and_b32 v69, 0xffff0000, v70
    v_lshlrev_b32 v70, 16, v71
    v_and_b32 v71, 0xffff0000, v71
    s_movk_i32 s45, 0x4000
    s_waitcnt vmcnt(11)
    ds_read_b128 v[140:143], v18 offset:64
    ds_read_b32 v209, v18 offset:80
    s_mul_i32 s66, s20, 229376
    ds_read_b64_tr_b16 a[0:1], v40 offset:0
    s_add_u32 s66, s66, 2097152
    s_lshl_b32 s46, s22, 12
    ds_read_b64_tr_b16 a[2:3], v40 offset:256
    s_add_u32 s10, s66, s46
    ds_read_b64_tr_b16 a[4:5], v41 offset:0
    buffer_load_dwordx4 v44, s[36:39], s3 offen offset:2048 lds
    v_lshlrev_b32 v72, 16, v76
    v_and_b32 v73, 0xffff0000, v76
    v_lshlrev_b32 v74, 16, v77
    v_and_b32 v75, 0xffff0000, v77
    v_lshlrev_b32 v76, 16, v78
    v_and_b32 v77, 0xffff0000, v78
    v_lshlrev_b32 v78, 16, v79
    v_and_b32 v79, 0xffff0000, v79
    s_mul_i32 s46, s21, 28672
    s_add_u32 s49, s10, s46
    ds_read_b64_tr_b16 a[6:7], v41 offset:256
    ds_read_b64_tr_b16 a[8:9], v40 offset:2048
    ds_read_b64_tr_b16 a[10:11], v40 offset:2304
    buffer_load_dwordx4 v45, s[36:39], s3 offen offset:3072 lds
    ds_read_b128 v[148:151], v18 offset:32
    s_add_u32 s50, s66, s46
    s_lshl_b32 s46, s67, 10
    ds_read_b32 v210, v18 offset:48
    v_lshlrev_b32 v80, 16, v84
    v_and_b32 v81, 0xffff0000, v84
    v_lshlrev_b32 v82, 16, v85
    v_and_b32 v83, 0xffff0000, v85
    v_lshlrev_b32 v84, 16, v86
    v_and_b32 v85, 0xffff0000, v86
    v_lshlrev_b32 v86, 16, v87
    v_and_b32 v87, 0xffff0000, v87
    s_add_u32 s50, s50, s46
    s_mul_i32 s46, s68, 6144
    ds_read_b64_tr_b16 a[12:13], v41 offset:2048
    ds_read_b64_tr_b16 a[14:15], v41 offset:2304
    buffer_load_dwordx4 v46, s[36:39], s3 offen offset:0 lds
    ds_read_b128 v[156:159], v18 offset:0
    s_add_u32 s50, s50, s46
    ds_read_b32 v211, v18 offset:16
    v_lshlrev_b32 v88, 16, v92
    v_and_b32 v89, 0xffff0000, v92
    v_lshlrev_b32 v90, 16, v93
    v_and_b32 v91, 0xffff0000, v93
    v_lshlrev_b32 v92, 16, v94
    v_and_b32 v93, 0xffff0000, v94
    v_lshlrev_b32 v94, 16, v95
    v_and_b32 v95, 0xffff0000, v95
    s_waitcnt lgkmcnt(9)
    s_add_u32 s54, s50, 0x4800
    ds_read_b128 v[164:167], v19 offset:96
    ds_read_b32 v212, v19 offset:112
    v_lshlrev_b32 v96, 16, v100
    v_and_b32 v97, 0xffff0000, v100
    v_lshlrev_b32 v98, 16, v101
    v_and_b32 v99, 0xffff0000, v101
    v_lshlrev_b32 v100, 16, v102
    v_and_b32 v101, 0xffff0000, v102
    v_lshlrev_b32 v102, 16, v103
    v_and_b32 v103, 0xffff0000, v103
    s_lshl_b32 s46, s67, 12
    s_add_u32 s50, s50, s46
    ds_read_b128 v[172:175], v19 offset:64
    ds_read_b32 v213, v19 offset:80
    v_lshlrev_b32 v104, 16, v108
    v_and_b32 v105, 0xffff0000, v108
    v_lshlrev_b32 v106, 16, v109
    v_and_b32 v107, 0xffff0000, v109
    v_lshlrev_b32 v108, 16, v110
    v_and_b32 v109, 0xffff0000, v110
    v_lshlrev_b32 v110, 16, v111
    v_and_b32 v111, 0xffff0000, v111
    s_add_u32 s50, s50, 0x4000
    s_xor_b32 s51, s50, 0x400
    ds_read_b128 v[180:183], v19 offset:32
    v_xor_b32 v40, s19, v40
    s_mul_i32 s47, s22, 57344
    s_add_u32 s47, s47, s66
    ds_read_b32 v214, v19 offset:48
    v_lshlrev_b32 v112, 16, v116
    v_and_b32 v113, 0xffff0000, v116
    v_lshlrev_b32 v114, 16, v117
    v_and_b32 v115, 0xffff0000, v117
    v_lshlrev_b32 v116, 16, v118
    v_and_b32 v117, 0xffff0000, v118
    v_lshlrev_b32 v118, 16, v119
    v_and_b32 v119, 0xffff0000, v119
    s_lshl_b32 s46, s68, 10
    s_add_u32 s47, s47, s46
    ds_read_b128 v[188:191], v19 offset:0
    ds_read_b32 v215, v19 offset:16
    v_lshlrev_b32 v120, 16, v124
    v_and_b32 v121, 0xffff0000, v124
    v_lshlrev_b32 v122, 16, v125
    v_and_b32 v123, 0xffff0000, v125
    v_lshlrev_b32 v124, 16, v126
    v_and_b32 v125, 0xffff0000, v126
    v_lshlrev_b32 v126, 16, v127
    v_and_b32 v127, 0xffff0000, v127
    v_sub_f32 v25, v25, v26
    v_lshrrev_b32 v14, 4, v1
    v_lshlrev_b32 v0, 3, v14
    v_add_u32 v240, s64, v0
    v_add_u32 v252, s65, v0
    v_add_u32 v248, s19, v252
    v_subrev_u32 v252, s19, v252
    s_xor_b32 s11, s47, 0x400
    s_lshr_b32 s46, s21, 1
    s_xor_b32 s46, s46, s22
    global_load_dwordx2 v[242:243], v240, s[52:53] offset:0
    v_xor_b32 v41, s19, v41
    s_waitcnt vmcnt(11)
    s_and_b32 s46, s46, 1
    ds_read_b64_tr_b16 a[128:129], v40 offset:4096
    ds_read_b64_tr_b16 a[130:131], v40 offset:4352
    ds_read_b64_tr_b16 a[132:133], v41 offset:4096
    ds_read_b64_tr_b16 a[134:135], v41 offset:4352
    global_load_dwordx2 v[246:247], v240, s[52:53] offset:32
    s_lshl_b32 s46, s46, 10
    s_waitcnt lgkmcnt(4)
    s_barrier
    ds_read_b64_tr_b16 a[136:137], v40 offset:6144
    ds_read_b64_tr_b16 a[138:139], v40 offset:6400
    ds_read_b64_tr_b16 a[140:141], v41 offset:6144
    global_load_dwordx2 v[250:251], v248, s[52:53] offset:0
    v_dot2_f32_bf16 v128, v208, s16, v64 neg_lo:[0,0,1]
    v_dot2_f32_bf16 v129, v135, s17, v65 neg_lo:[0,0,1]
    v_dot2_f32_bf16 v130, v135, s16, v66 neg_lo:[0,0,1]
    v_dot2_f32_bf16 v131, v134, s17, v67 neg_lo:[0,0,1]
    v_dot2_f32_bf16 v135, v132, s17, v71 neg_lo:[0,0,1]
    v_dot2_f32_bf16 v132, v134, s16, v68 neg_lo:[0,0,1]
    v_dot2_f32_bf16 v134, v133, s16, v70 neg_lo:[0,0,1]
    s_xor_b32 s55, s67, s68
    s_xor_b32 s55, s55, 1
    ds_read_b64_tr_b16 a[142:143], v41 offset:6400
    global_load_dwordx2 v[254:255], v252, s[52:53] offset:32
    s_add_u32 m0, s14, 16384
    s_add_u32 s3, s73, s64
    s_cmp_eq_u32 s74, 7
    s_cselect_b64 s[0:1], 15, 0
    v_dot2_f32_bf16 v133, v133, s17, v69 neg_lo:[0,0,1]
    v_dot2_f32_bf16 v136, v209, s16, v72 neg_lo:[0,0,1]
    v_dot2_f32_bf16 v137, v143, s17, v73 neg_lo:[0,0,1]
    s_lshl_b32 s55, s55, 15
    s_or_b32 s55, s55, s46
    buffer_load_dwordx4 v43, s[36:39], s3 offen offset:1024 lds
    v_cndmask_b32 v46, v42, v47, s[0:1]
    v_dot2_f32_bf16 v138, v143, s16, v74 neg_lo:[0,0,1]
    v_dot2_f32_bf16 v139, v142, s17, v75 neg_lo:[0,0,1]
    v_dot2_f32_bf16 v143, v140, s17, v79 neg_lo:[0,0,1]
    v_dot2_f32_bf16 v140, v142, s16, v76 neg_lo:[0,0,1]
    v_dot2_f32_bf16 v142, v141, s16, v78 neg_lo:[0,0,1]
    v_dot2_f32_bf16 v141, v141, s17, v77 neg_lo:[0,0,1]
    buffer_load_dwordx4 v44, s[36:39], s3 offen offset:2048 lds
    v_dot2_f32_bf16 v144, v210, s16, v80 neg_lo:[0,0,1]
    v_dot2_f32_bf16 v145, v151, s17, v81 neg_lo:[0,0,1]
    v_dot2_f32_bf16 v146, v151, s16, v82 neg_lo:[0,0,1]
    v_dot2_f32_bf16 v147, v150, s17, v83 neg_lo:[0,0,1]
    v_dot2_f32_bf16 v151, v148, s17, v87 neg_lo:[0,0,1]
    v_dot2_f32_bf16 v148, v150, s16, v84 neg_lo:[0,0,1]
    v_dot2_f32_bf16 v150, v149, s16, v86 neg_lo:[0,0,1]
    buffer_load_dwordx4 v45, s[36:39], s3 offen offset:3072 lds
    v_dot2_f32_bf16 v149, v149, s17, v85 neg_lo:[0,0,1]
    v_dot2_f32_bf16 v152, v211, s16, v88 neg_lo:[0,0,1]
    v_dot2_f32_bf16 v153, v159, s17, v89 neg_lo:[0,0,1]
    v_dot2_f32_bf16 v154, v159, s16, v90 neg_lo:[0,0,1]
    v_dot2_f32_bf16 v155, v158, s17, v91 neg_lo:[0,0,1]
    v_xor_b32 v40, s19, v40
    v_dot2_f32_bf16 v159, v156, s17, v95 neg_lo:[0,0,1]
    buffer_load_dwordx4 v46, s[36:39], s3 offen offset:0 lds
    s_add_u32 m0, s14, 0
    s_add_u32 s3, s73, s64
    s_cmp_eq_u32 s74, 0
    s_cselect_b64 s[0:1], 15, 0
    v_dot2_f32_bf16 v156, v158, s16, v92 neg_lo:[0,0,1]
    v_dot2_f32_bf16 v158, v157, s16, v94 neg_lo:[0,0,1]
    v_dot2_f32_bf16 v157, v157, s17, v93 neg_lo:[0,0,1]
    buffer_load_dwordx4 v49, s[36:39], s3 offen offset:1024 lds
    v_cndmask_b32 v46, v48, v47, s[0:1]
    v_dot2_f32_bf16 v160, v212, s16, v96 neg_lo:[0,0,1]
    v_dot2_f32_bf16 v161, v167, s17, v97 neg_lo:[0,0,1]
    v_dot2_f32_bf16 v162, v167, s16, v98 neg_lo:[0,0,1]
    v_dot2_f32_bf16 v163, v166, s17, v99 neg_lo:[0,0,1]
    v_dot2_f32_bf16 v167, v164, s17, v103 neg_lo:[0,0,1]
    v_dot2_f32_bf16 v164, v166, s16, v100 neg_lo:[0,0,1]
    buffer_load_dwordx4 v50, s[36:39], s3 offen offset:2048 lds
    v_dot2_f32_bf16 v166, v165, s16, v102 neg_lo:[0,0,1]
    v_dot2_f32_bf16 v165, v165, s17, v101 neg_lo:[0,0,1]
    v_dot2_f32_bf16 v168, v213, s16, v104 neg_lo:[0,0,1]
    v_dot2_f32_bf16 v169, v175, s17, v105 neg_lo:[0,0,1]
    v_dot2_f32_bf16 v170, v175, s16, v106 neg_lo:[0,0,1]
    v_dot2_f32_bf16 v171, v174, s17, v107 neg_lo:[0,0,1]
    v_dot2_f32_bf16 v175, v172, s17, v111 neg_lo:[0,0,1]
    buffer_load_dwordx4 v51, s[36:39], s3 offen offset:3072 lds
    v_xor_b32 v41, s19, v41
    v_dot2_f32_bf16 v172, v174, s16, v108 neg_lo:[0,0,1]
    v_dot2_f32_bf16 v174, v173, s16, v110 neg_lo:[0,0,1]
    v_dot2_f32_bf16 v173, v173, s17, v109 neg_lo:[0,0,1]
    v_dot2_f32_bf16 v176, v214, s16, v112 neg_lo:[0,0,1]
    v_dot2_f32_bf16 v177, v183, s17, v113 neg_lo:[0,0,1]
    v_dot2_f32_bf16 v178, v183, s16, v114 neg_lo:[0,0,1]
    s_waitcnt vmcnt(15)
    ds_read_b64_tr_b16 a[16:17], v40 offset:8192
    ds_read_b64_tr_b16 a[18:19], v40 offset:8448
    ds_read_b64_tr_b16 a[20:21], v41 offset:8192
    buffer_load_dwordx4 v46, s[36:39], s3 offen offset:0 lds
    s_waitcnt lgkmcnt(3)
    s_add_u32 m0, s14, 4096
    s_add_u32 s3, s72, s64
    s_cmp_eq_u32 s74, 1
    s_cselect_b64 s[0:1], 15, 0
    v_dot2_f32_bf16 v179, v182, s17, v115 neg_lo:[0,0,1]
    v_dot2_f32_bf16 v183, v180, s17, v119 neg_lo:[0,0,1]
    ds_read_b64_tr_b16 a[22:23], v41 offset:8448
    ds_read_b64_tr_b16 a[24:25], v40 offset:10240
    ds_read_b64_tr_b16 a[26:27], v40 offset:10496
    buffer_load_dwordx4 v49, s[36:39], s3 offen offset:1024 lds
    v_cndmask_b32 v46, v48, v47, s[0:1]
    v_dot2_f32_bf16 v180, v182, s16, v116 neg_lo:[0,0,1]
    v_dot2_f32_bf16 v182, v181, s16, v118 neg_lo:[0,0,1]
    v_dot2_f32_bf16 v181, v181, s17, v117 neg_lo:[0,0,1]
    v_dot2_f32_bf16 v184, v215, s16, v120 neg_lo:[0,0,1]
    v_dot2_f32_bf16 v185, v191, s17, v121 neg_lo:[0,0,1]
    v_dot2_f32_bf16 v186, v191, s16, v122 neg_lo:[0,0,1]
    ds_read_b64_tr_b16 a[28:29], v41 offset:10240
    ds_read_b64_tr_b16 a[30:31], v41 offset:10496
    s_waitcnt vmcnt(13)
    ds_read_b64_tr_b16 a[32:33], v40 offset:12288
    buffer_load_dwordx4 v50, s[36:39], s3 offen offset:2048 lds
    v_dot2_f32_bf16 v187, v190, s17, v123 neg_lo:[0,0,1]
    v_dot2_f32_bf16 v191, v188, s17, v127 neg_lo:[0,0,1]
    v_dot2_f32_bf16 v188, v190, s16, v124 neg_lo:[0,0,1]
    v_dot2_f32_bf16 v190, v189, s16, v126 neg_lo:[0,0,1]
    v_dot2_f32_bf16 v189, v189, s17, v125 neg_lo:[0,0,1]
    v_lshl_add_u32 v4, v5, 1, s67
    v_cvt_f32_u32 v4, v4
    ds_read_b64_tr_b16 a[34:35], v40 offset:12544
    ds_read_b64_tr_b16 a[36:37], v41 offset:12288
    ds_read_b64_tr_b16 a[38:39], v41 offset:12544
    buffer_load_dwordx4 v51, s[36:39], s3 offen offset:3072 lds
    v_mul_f32 v4, 0x3c800000, v4
    v_lshlrev_b32 v7, 2, v2
    v_cvt_f32_u32 v7, v7
    v_mul_f32 v7, v7, v4
    v_mul_f32 v8, 0x40a00000, v4
    s_lshl_b32 s16, s67, 31
    s_or_b32 s16, s16, 0x3f800000
    ds_read_b64_tr_b16 a[40:41], v40 offset:14336
    ds_read_b64_tr_b16 a[42:43], v40 offset:14592
    ds_read_b64_tr_b16 a[44:45], v41 offset:14336
    buffer_load_dwordx4 v46, s[36:39], s3 offen offset:0 lds
    s_waitcnt lgkmcnt(7)
    s_add_u32 m0, s14, 8192
    s_add_u32 s3, s71, s64
    s_cmp_eq_u32 s74, 2
    s_cselect_b64 s[0:1], 15, 0
    v_mov_b32 v9, s16
    s_lshr_b32 s42, s40, 1
    ds_read_b64_tr_b16 a[46:47], v41 offset:14592
    buffer_load_dwordx4 v49, s[36:39], s3 offen offset:1024 lds
    v_cndmask_b32 v46, v48, v47, s[0:1]
    s_xor_b32 s43, s42, 0x1f800000
    s_xor_b32 s42, s42, 0x5f800000
    v_cos_f32 v10, v7
    v_sin_f32 v11, v7
    v_add_f32 v7, v7, v4
    v_cndmask_b32 v11, v11, v9, s[6:7]
    v_pk_mul_f32 v[10:11], v[10:11], s[42:43]
    v_cvt_pk_bf16_f32 v192, v10, v11
    v_cos_f32 v10, v7
    buffer_load_dwordx4 v50, s[36:39], s3 offen offset:2048 lds
    v_sin_f32 v11, v7
    v_add_f32 v7, v7, v4
    v_pk_mul_f32 v[10:11], v[10:11], s[42:43]
    v_cvt_pk_bf16_f32 v193, v10, v11
    v_cos_f32 v10, v7
    v_sin_f32 v11, v7
    v_add_f32 v7, v7, v4
    v_pk_mul_f32 v[10:11], v[10:11], s[42:43]
    v_cvt_pk_bf16_f32 v194, v10, v11
    v_cos_f32 v10, v7
    s_waitcnt vmcnt(10)
    ds_read_b64_tr_b16 a[48:49], v40 offset:16384
    ds_read_b64_tr_b16 a[50:51], v40 offset:16640
    ds_read_b64_tr_b16 a[52:53], v41 offset:16384
    buffer_load_dwordx4 v51, s[36:39], s3 offen offset:3072 lds
    v_sin_f32 v11, v7
    v_add_f32 v7, v7, v8
    v_pk_mul_f32 v[10:11], v[10:11], s[42:43]
    v_cvt_pk_bf16_f32 v195, v10, v11
    v_cos_f32 v10, v7
    v_sin_f32 v11, v7
    v_add_f32 v7, v7, v4
    v_pk_mul_f32 v[10:11], v[10:11], s[42:43]
    v_cvt_pk_bf16_f32 v196, v10, v11
    ds_read_b64_tr_b16 a[54:55], v41 offset:16640
    ds_read_b64_tr_b16 a[56:57], v40 offset:18432
    ds_read_b64_tr_b16 a[58:59], v40 offset:18688
    buffer_load_dwordx4 v46, s[36:39], s3 offen offset:0 lds
    s_waitcnt lgkmcnt(6)
    s_add_u32 m0, s14, 12288
    s_add_u32 s3, s70, s64
    s_cmp_eq_u32 s74, 3
    s_cselect_b64 s[0:1], 15, 0
    v_cos_f32 v10, v7
    v_sin_f32 v11, v7
    v_add_f32 v7, v7, v4
    v_pk_mul_f32 v[10:11], v[10:11], s[42:43]
    v_cvt_pk_bf16_f32 v197, v10, v11
    ds_read_b64_tr_b16 a[60:61], v41 offset:18432
    ds_read_b64_tr_b16 a[62:63], v41 offset:18688
    buffer_load_dwordx4 v49, s[36:39], s3 offen offset:1024 lds
    v_cndmask_b32 v46, v48, v47, s[0:1]
    v_cos_f32 v10, v7
    v_sin_f32 v11, v7
    v_add_f32 v7, v7, v4
    v_pk_mul_f32 v[10:11], v[10:11], s[42:43]
    v_cvt_pk_bf16_f32 v198, v10, v11
    v_cos_f32 v10, v7
    v_sin_f32 v11, v7
    v_add_f32 v7, v7, v8
    buffer_load_dwordx4 v50, s[36:39], s3 offen offset:2048 lds
    v_pk_mul_f32 v[10:11], v[10:11], s[42:43]
    v_cvt_pk_bf16_f32 v199, v10, v11
    v_cos_f32 v10, v7
    v_sin_f32 v11, v7
    v_add_f32 v7, v7, v4
    v_pk_mul_f32 v[10:11], v[10:11], s[42:43]
    v_cvt_pk_bf16_f32 v200, v10, v11
    v_cos_f32 v10, v7
    v_sin_f32 v11, v7
    v_add_f32 v7, v7, v4
    s_waitcnt vmcnt(10)
    ds_read_b64_tr_b16 a[64:65], v40 offset:0
    ds_read_b64_tr_b16 a[66:67], v40 offset:256
    ds_read_b64_tr_b16 a[68:69], v41 offset:0
    buffer_load_dwordx4 v51, s[36:39], s3 offen offset:3072 lds
    v_pk_mul_f32 v[10:11], v[10:11], s[42:43]
    v_cvt_pk_bf16_f32 v201, v10, v11
    v_cos_f32 v10, v7
    v_sin_f32 v11, v7
    v_add_f32 v7, v7, v4
    v_pk_mul_f32 v[10:11], v[10:11], s[42:43]
    v_cvt_pk_bf16_f32 v202, v10, v11
    v_cos_f32 v10, v7
    ds_read_b64_tr_b16 a[70:71], v41 offset:256
    ds_read_b64_tr_b16 a[72:73], v40 offset:2048
    ds_read_b64_tr_b16 a[74:75], v40 offset:2304
    buffer_load_dwordx4 v46, s[36:39], s3 offen offset:0 lds
    v_sin_f32 v11, v7
    v_add_f32 v7, v7, v8
    v_pk_mul_f32 v[10:11], v[10:11], s[42:43]
    v_cvt_pk_bf16_f32 v203, v10, v11
    v_cos_f32 v10, v7
    v_sin_f32 v11, v7
    v_add_f32 v7, v7, v4
    v_pk_mul_f32 v[10:11], v[10:11], s[42:43]
    v_cvt_pk_bf16_f32 v204, v10, v11
    v_cos_f32 v10, v7
    v_sin_f32 v11, v7
    v_add_f32 v7, v7, v4
    v_pk_mul_f32 v[10:11], v[10:11], s[42:43]
    v_cvt_pk_bf16_f32 v205, v10, v11
    v_cos_f32 v10, v7
    v_sin_f32 v11, v7
    s_add_u32 s3, s24, 0
    s_add_u32 m0, s25, 0
    ds_read_b64_tr_b16 a[76:77], v41 offset:2048
    ds_read_b64_tr_b16 a[78:79], v41 offset:2304
    buffer_load_dwordx4 v3, s[32:35], s3 offen offset:0 sc1 lds
    v_add_f32 v7, v7, v4
    v_pk_mul_f32 v[10:11], v[10:11], s[42:43]
    v_cvt_pk_bf16_f32 v206, v10, v11
    v_cos_f32 v10, v7
    v_sin_f32 v11, v7
    buffer_load_dwordx4 v3, s[32:35], s3 offen offset:1024 sc1 lds
    s_add_u32 s3, s3, 2048
    s_add_u32 m0, s26, 0
    v_add_f32 v7, v7, v8
    v_pk_mul_f32 v[10:11], v[10:11], s[42:43]
    v_cvt_pk_bf16_f32 v207, v10, v11
    s_lshl_b32 s16, s68, 1
    s_or_b32 s16, s16, s5
    s_mov_b32 s9, 0
    s_cmp_eq_u32 s16, 0
    s_cselect_b32 s6, -1, 0
    s_waitcnt vmcnt(10)
    ds_read_b64_tr_b16 a[80:81], v40 offset:4096
    ds_read_b64_tr_b16 a[82:83], v40 offset:4352
    ds_read_b64_tr_b16 a[84:85], v41 offset:4096
    buffer_load_dwordx4 v3, s[32:35], s3 offen offset:0 sc1 lds
    s_cmp_eq_u32 s16, 1
    s_cselect_b32 s8, -1, 0
    s_mov_b32 s16, 151552
    v_lshl_add_u32 v16, v16, 5, s16
    s_lshl_b32 s16, s68, 3
    v_lshl_add_u32 v6, v2, 4, s16
    v_add_u32 v6, v6, v16
    s_movk_i32 s17, 0x1be4
    v_and_b32 v4, 14, v12
    v_bfe_u32 v4, s17, v4, 2
    v_xor_b32 v4, v4, v2
    ds_read_b64_tr_b16 a[86:87], v41 offset:4352
    ds_read_b64_tr_b16 a[88:89], v40 offset:6144
    ds_read_b64_tr_b16 a[90:91], v40 offset:6400
    buffer_load_dwordx4 v3, s[32:35], s3 offen offset:1024 sc1 lds
    s_add_u32 s3, s24, 4096
    s_add_u32 m0, s25, 2048
    v_and_b32 v7, 31, v12
    v_lshl_add_u32 v7, v7, 6, s25
    v_lshl_add_u32 v20, v4, 4, v7
    v_xor_b32 v21, 32, v20
    v_and_b32 v4, 14, v13
    v_bfe_u32 v4, s17, v4, 2
    v_xor_b32 v4, v4, v2
    v_and_b32 v7, 31, v13
    v_lshl_add_u32 v7, v7, 6, s26
    v_lshl_add_u32 v18, v4, 4, v7
    ds_read_b64_tr_b16 a[92:93], v41 offset:6144
    ds_read_b64_tr_b16 a[94:95], v41 offset:6400
    buffer_load_dwordx4 v3, s[32:35], s3 offen offset:0 sc1 lds
    v_xor_b32 v19, 32, v18
    v_lshlrev_b32 v7, 9, v2
    v_bfe_u32 v4, v1, 3, 1
    v_lshl_add_u32 v7, v4, 7, v7
    v_bfe_u32 v4, v1, 2, 1
    v_lshl_add_u32 v7, v4, 3, v7
    v_bfe_u32 v4, v1, 4, 1
    v_lshl_add_u32 v7, v4, 6, v7
    v_bfe_u32 v4, v1, 0, 1
    v_lshl_add_u32 v7, v4, 5, v7
    v_bfe_u32 v4, v1, 1, 1
    v_lshl_add_u32 v7, v4, 4, v7
    buffer_load_dwordx4 v3, s[32:35], s3 offen offset:1024 sc1 lds
    s_add_u32 m0, s26, 0
    v_add_u32 v22, s25, v7
    v_add_u32 v23, s26, v7
    v_and_b32 v15, 15, v1
    v_and_b32 v4, 14, v1
    v_bfe_u32 v60, s17, v4, 2
    v_xor_b32 v4, v60, v14
    s_lshl_b32 s16, s68, 15
    s_lshl_b32 s17, s67, 10
    s_add_u32 s69, s16, s17
    v_lshl_add_u32 v13, v15, 6, s69
    v_lshl_add_u32 v13, v4, 4, v13
    v_xor_b32 v12, 0x400, v13
    v_xor_b32 v11, 0x8000, v13
    s_waitcnt vmcnt(10)
    ds_read_b64_tr_b16 a[96:97], v40 offset:8192
    ds_read_b64_tr_b16 a[98:99], v40 offset:8448
    ds_read_b64_tr_b16 a[100:101], v41 offset:8192
    buffer_load_dwordx4 v3, s[32:35], s3 offen offset:2048 sc1 lds
    v_xor_b32 v10, 0x8400, v13
    v_lshrrev_b32 v4, 3, v1
    v_and_b32 v7, 6, v4
    v_and_b32 v62, 7, v1
    v_xor_b32 v7, v7, v62
    v_lshlrev_b32 v4, 10, v4
    v_lshl_add_u32 v52, v7, 4, v4
    v_add_u32 v53, 7168, v52
    v_add_u32 v54, 7168, v53
    v_add_u32 v55, 7168, v54
    v_lshrrev_b32 v4, 2, v1
    ds_read_b64_tr_b16 a[102:103], v41 offset:8448
    ds_read_b64_tr_b16 a[104:105], v40 offset:10240
    ds_read_b64_tr_b16 a[106:107], v40 offset:10496
    buffer_load_dwordx4 v3, s[32:35], s3 offen offset:3072 sc1 lds
    s_add_u32 s3, s27, 0
    s_add_u32 m0, s25, 4096
    v_and_b32 v7, 6, v4
    v_and_b32 v8, 3, v1
    v_lshl_add_u32 v4, v4, 7, s14
    v_lshl_add_u32 v4, v8, 3, v4
    v_lshl_add_u32 v56, v7, 4, v4
    v_xor_b32 v57, 32, v56
    v_xor_b32 v58, 64, v56
    v_xor_b32 v59, 96, v56
    v_min_u32 v63, 55, v1
    v_and_b32 v4, 3, v63
    ds_read_b64_tr_b16 a[108:109], v41 offset:10240
    ds_read_b64_tr_b16 a[110:111], v41 offset:10496
    buffer_load_dwordx4 v3, s[32:35], s3 offen offset:0 sc1 lds
    v_lshrrev_b32 v63, 2, v63
    v_lshlrev_b32 v63, 10, v63
    v_lshl_add_u32 v63, v4, 7, v63
    v_add_u32 v0, s18, v0
    v_lshl_add_u32 v4, v1, 31, s40
    v_lshrrev_b32 v61, 16, v4
    v_or_b32 v61, v61, v4
    v_lshlrev_b32 v240, 16, v242
    v_and_b32 v241, 0xffff0000, v242
    v_lshlrev_b32 v242, 16, v243
    v_and_b32 v243, 0xffff0000, v243
    v_lshlrev_b32 v244, 16, v246
    v_and_b32 v245, 0xffff0000, v246
    buffer_load_dwordx4 v3, s[32:35], s3 offen offset:1024 sc1 lds
    s_add_u32 m0, s26, 2048
    v_lshlrev_b32 v246, 16, v247
    v_and_b32 v247, 0xffff0000, v247
    v_lshlrev_b32 v248, 16, v250
    v_and_b32 v249, 0xffff0000, v250
    v_lshlrev_b32 v250, 16, v251
    v_and_b32 v251, 0xffff0000, v251
    v_lshlrev_b32 v252, 16, v254
    v_and_b32 v253, 0xffff0000, v254
    v_lshlrev_b32 v254, 16, v255
    v_and_b32 v255, 0xffff0000, v255
    s_waitcnt vmcnt(10)
    ds_read_b64_tr_b16 a[112:113], v40 offset:12288
    ds_read_b64_tr_b16 a[114:115], v40 offset:12544
    ds_read_b64_tr_b16 a[116:117], v41 offset:12288
    ds_read_b64_tr_b16 a[118:119], v41 offset:12544
    ds_read_b64_tr_b16 a[120:121], v40 offset:14336
    ds_read_b64_tr_b16 a[122:123], v40 offset:14592
    ds_read_b64_tr_b16 a[124:125], v41 offset:14336
    ds_read_b64_tr_b16 a[126:127], v41 offset:14592
    buffer_load_dwordx4 v3, s[32:35], s3 offen offset:2048 sc1 lds
    buffer_load_dwordx4 v3, s[32:35], s3 offen offset:3072 sc1 lds
    s_add_u32 s3, s27, 4096
    s_add_u32 m0, s25, 6144
    s_nop 0
    buffer_load_dwordx4 v3, s[32:35], s3 offen offset:0 sc1 lds
    buffer_load_dwordx4 v3, s[32:35], s3 offen offset:1024 sc1 lds
    s_add_u32 m0, s26, 4096
    s_nop 0
    buffer_load_dwordx4 v3, s[32:35], s3 offen offset:2048 sc1 lds
    buffer_load_dwordx4 v3, s[32:35], s3 offen offset:3072 sc1 lds
    s_waitcnt lgkmcnt(0)
    s_add_u32 m0, s14, 16384
    s_add_u32 s3, s71, s65
    s_cmp_eq_u32 s74, 5
    s_cselect_b64 s[0:1], 15, 0
    s_mov_b32 s4, 0x2000
    s_waitcnt vmcnt(12)
    ds_read_b64_tr_b16 v[224:225], v22 offset:0
    ds_read_b64_tr_b16 v[226:227], v22 offset:256
    ds_read_b64_tr_b16 v[228:229], v22 offset:1024
    ds_read_b64_tr_b16 v[230:231], v22 offset:1280
    ds_read_b64_tr_b16 v[232:233], v23 offset:0
    ds_read_b64_tr_b16 v[234:235], v23 offset:256
    ds_read_b64_tr_b16 v[236:237], v23 offset:1024
    ds_read_b64_tr_b16 v[238:239], v23 offset:1280
    s_waitcnt lgkmcnt(4)
    v_mfma_f32_32x32x16_bf16 v[208:223], v[224:227], v[192:195], v[64:79]
    v_bitop3_b32 v26, v224, v225, s41 bitop3:0x7e
    v_bitop3_b32 v27, v226, v227, s41 bitop3:0x7e
    v_mfma_f32_32x32x16_bf16 v[208:223], v[228:231], v[196:199], v[208:223]
    v_bitop3_b32 v28, v228, v229, s41 bitop3:0x7e
    v_bitop3_b32 v29, v230, v231, s41 bitop3:0x7e
    v_or3_b32 v26, v26, v27, v28
    s_waitcnt lgkmcnt(0)
    v_mfma_f32_32x32x16_bf16 v[208:223], v[232:235], v[200:203], v[208:223]
    v_bitop3_b32 v27, v232, v233, s41 bitop3:0x7e
    v_bitop3_b32 v28, v234, v235, s41 bitop3:0x7e
    v_or3_b32 v26, v26, v29, v27
    v_bitop3_b32 v27, v236, v237, s41 bitop3:0x7e
    v_mfma_f32_32x32x16_bf16 v[208:223], v[236:239], v[204:207], v[208:223]
    v_bitop3_b32 v29, v238, v239, s41 bitop3:0x7e
    v_or3_b32 v26, v26, v27, v28
    v_bitop3_b32 v26, v26, v29, s48 bitop3:0xa8
    v_cmp_ne_u32 vcc, 0, v26
    s_waitcnt vmcnt(8)
fnet_kernel_stg53:
    ds_read_b64_tr_b16 v[224:225], v22 offset:2048
    ds_read_b64_tr_b16 v[226:227], v22 offset:2304
    ds_read_b64_tr_b16 v[228:229], v22 offset:3072
    ds_read_b64_tr_b16 v[230:231], v22 offset:3328
    ds_read_b64_tr_b16 v[232:233], v23 offset:2048
    ds_read_b64_tr_b16 v[234:235], v23 offset:2304
    ds_read_b64_tr_b16 v[236:237], v23 offset:3072
    ds_read_b64_tr_b16 v[238:239], v23 offset:3328
    v_pk_add_f32 v[26:27], v[208:209], v[210:211]
    v_pk_add_f32 v[28:29], v[212:213], v[214:215]
    v_pk_add_f32 v[26:27], v[26:27], v[216:217]
    v_pk_add_f32 v[28:29], v[28:29], v[218:219]
    v_pk_add_f32 v[26:27], v[26:27], v[220:221]
    v_pk_add_f32 v[28:29], v[28:29], v[222:223]
    v_pk_add_f32 v[26:27], v[26:27], v[28:29]
    v_add_f32 v24, v26, v27
    s_cbranch_vccnz fnet_kernel_rty57
fnet_kernel_cont61:
    v_pk_add_f32 v[128:129], v[128:129], v[208:209]
    v_cndmask_b32 v39, v208, v64, s[6:7]
    v_sub_f32 v38, v39, v208
    v_mov_b32 v208, v39
    v_pk_add_f32 v[130:131], v[130:131], v[210:211]
    v_pk_add_f32 v[132:133], v[132:133], v[212:213]
    v_pk_add_f32 v[134:135], v[134:135], v[214:215]
    s_waitcnt lgkmcnt(4)
    v_mfma_f32_32x32x16_bf16 v[64:79], v[224:227], v[192:195], v[80:95]
    v_bitop3_b32 v26, v224, v225, s41 bitop3:0x7e
    v_bitop3_b32 v27, v226, v227, s41 bitop3:0x7e
    v_pk_add_f32 v[136:137], v[136:137], v[216:217]
    v_pk_add_f32 v[138:139], v[138:139], v[218:219]
    buffer_load_dwordx4 v43, s[36:39], s3 offen offset:1024 lds
    v_cndmask_b32 v46, v42, v47, s[0:1]
    v_pk_add_f32 v[140:141], v[140:141], v[220:221]
    v_pk_add_f32 v[142:143], v[142:143], v[222:223]
    v_mfma_f32_32x32x16_bf16 v[64:79], v[228:231], v[196:199], v[64:79]
    v_bitop3_b32 v28, v228, v229, s41 bitop3:0x7e
    v_bitop3_b32 v29, v230, v231, s41 bitop3:0x7e
    v_or3_b32 v26, v26, v27, v28
    v_pk_mul_f32 v[30:31], v[208:209], v[208:209]
    v_pk_mul_f32 v[34:35], v[128:129], v[128:129]
    v_pk_mul_f32 v[32:33], v[210:211], v[210:211]
    v_pk_mul_f32 v[36:37], v[130:131], v[130:131]
    s_waitcnt lgkmcnt(0)
    v_mfma_f32_32x32x16_bf16 v[64:79], v[232:235], v[200:203], v[64:79]
    v_bitop3_b32 v27, v232, v233, s41 bitop3:0x7e
    buffer_load_dwordx4 v44, s[36:39], s3 offen offset:2048 lds
    v_bitop3_b32 v28, v234, v235, s41 bitop3:0x7e
    v_or3_b32 v26, v26, v29, v27
    v_bitop3_b32 v27, v236, v237, s41 bitop3:0x7e
    v_pk_fma_f32 v[30:31], v[212:213], v[212:213], v[30:31]
    v_pk_fma_f32 v[34:35], v[132:133], v[132:133], v[34:35]
    v_pk_fma_f32 v[32:33], v[214:215], v[214:215], v[32:33]
    v_pk_fma_f32 v[36:37], v[134:135], v[134:135], v[36:37]
    v_mfma_f32_32x32x16_bf16 v[64:79], v[236:239], v[204:207], v[64:79]
    v_bitop3_b32 v29, v238, v239, s41 bitop3:0x7e
    v_or3_b32 v26, v26, v27, v28
    v_bitop3_b32 v26, v26, v29, s48 bitop3:0xa8
    v_cmp_ne_u32 vcc, 0, v26
    v_pk_fma_f32 v[30:31], v[216:217], v[216:217], v[30:31]
    v_pk_fma_f32 v[34:35], v[136:137], v[136:137], v[34:35]
    v_pk_fma_f32 v[32:33], v[218:219], v[218:219], v[32:33]
    buffer_load_dwordx4 v45, s[36:39], s3 offen offset:3072 lds
    v_pk_fma_f32 v[36:37], v[138:139], v[138:139], v[36:37]
    v_pk_fma_f32 v[30:31], v[220:221], v[220:221], v[30:31]
    v_pk_fma_f32 v[34:35], v[140:141], v[140:141], v[34:35]
    v_pk_fma_f32 v[32:33], v[222:223], v[222:223], v[32:33]
    v_pk_fma_f32 v[36:37], v[142:143], v[142:143], v[36:37]
    s_waitcnt vmcnt(7)
fnet_kernel_stg54:
    ds_read_b64_tr_b16 v[224:225], v22 offset:4096
    ds_read_b64_tr_b16 v[226:227], v22 offset:4352
    ds_read_b64_tr_b16 v[228:229], v22 offset:5120
    ds_read_b64_tr_b16 v[230:231], v22 offset:5376
    ds_read_b64_tr_b16 v[232:233], v23 offset:4096
    ds_read_b64_tr_b16 v[234:235], v23 offset:4352
    ds_read_b64_tr_b16 v[236:237], v23 offset:5120
    ds_read_b64_tr_b16 v[238:239], v23 offset:5376
    v_pk_add_f32 v[26:27], v[64:65], v[66:67]
    v_pk_add_f32 v[28:29], v[68:69], v[70:71]
    v_pk_add_f32 v[26:27], v[26:27], v[72:73]
    v_pk_add_f32 v[28:29], v[28:29], v[74:75]
    v_pk_add_f32 v[26:27], v[26:27], v[76:77]
    v_pk_add_f32 v[28:29], v[28:29], v[78:79]
    v_pk_add_f32 v[26:27], v[26:27], v[28:29]
    v_add_f32 v26, v26, v27
    s_cbranch_vccnz fnet_kernel_rty58
fnet_kernel_cont62:
    buffer_load_dwordx4 v46, s[36:39], s3 offen offset:0 lds
    s_add_u32 m0, s14, 0
    s_add_u32 s3, s72, s65
    s_cmp_eq_u32 s74, 6
    s_cselect_b64 s[0:1], 15, 0
    v_add_f32 v24, v24, v26
    v_pk_add_f32 v[144:145], v[144:145], v[64:65]
    v_pk_add_f32 v[146:147], v[146:147], v[66:67]
    buffer_load_dwordx4 v43, s[36:39], s3 offen offset:1024 lds
    v_cndmask_b32 v46, v42, v47, s[0:1]
    v_pk_add_f32 v[148:149], v[148:149], v[68:69]
    v_pk_add_f32 v[150:151], v[150:151], v[70:71]
    s_waitcnt lgkmcnt(4)
    v_mfma_f32_32x32x16_bf16 v[80:95], v[224:227], v[192:195], v[96:111]
    v_bitop3_b32 v26, v224, v225, s41 bitop3:0x7e
    v_bitop3_b32 v27, v226, v227, s41 bitop3:0x7e
    v_pk_add_f32 v[152:153], v[152:153], v[72:73]
    v_pk_add_f32 v[154:155], v[154:155], v[74:75]
    v_pk_add_f32 v[156:157], v[156:157], v[76:77]
    v_pk_add_f32 v[158:159], v[158:159], v[78:79]
    v_mfma_f32_32x32x16_bf16 v[80:95], v[228:231], v[196:199], v[80:95]
    buffer_load_dwordx4 v44, s[36:39], s3 offen offset:2048 lds
    v_bitop3_b32 v28, v228, v229, s41 bitop3:0x7e
    v_bitop3_b32 v29, v230, v231, s41 bitop3:0x7e
    v_or3_b32 v26, v26, v27, v28
    v_pk_fma_f32 v[30:31], v[64:65], v[64:65], v[30:31]
    v_pk_fma_f32 v[34:35], v[144:145], v[144:145], v[34:35]
    v_pk_fma_f32 v[32:33], v[66:67], v[66:67], v[32:33]
    v_pk_fma_f32 v[36:37], v[146:147], v[146:147], v[36:37]
    s_waitcnt lgkmcnt(0)
    v_mfma_f32_32x32x16_bf16 v[80:95], v[232:235], v[200:203], v[80:95]
    v_bitop3_b32 v27, v232, v233, s41 bitop3:0x7e
    v_bitop3_b32 v28, v234, v235, s41 bitop3:0x7e
    v_or3_b32 v26, v26, v29, v27
    v_bitop3_b32 v27, v236, v237, s41 bitop3:0x7e
    v_pk_fma_f32 v[30:31], v[68:69], v[68:69], v[30:31]
    v_pk_fma_f32 v[34:35], v[148:149], v[148:149], v[34:35]
    v_pk_fma_f32 v[32:33], v[70:71], v[70:71], v[32:33]
    buffer_load_dwordx4 v45, s[36:39], s3 offen offset:3072 lds
    v_pk_fma_f32 v[36:37], v[150:151], v[150:151], v[36:37]
    v_mfma_f32_32x32x16_bf16 v[80:95], v[236:239], v[204:207], v[80:95]
    v_bitop3_b32 v29, v238, v239, s41 bitop3:0x7e
    v_or3_b32 v26, v26, v27, v28
    v_bitop3_b32 v26, v26, v29, s48 bitop3:0xa8
    v_cmp_ne_u32 vcc, 0, v26
    v_pk_fma_f32 v[30:31], v[72:73], v[72:73], v[30:31]
    v_pk_fma_f32 v[34:35], v[152:153], v[152:153], v[34:35]
    v_pk_fma_f32 v[32:33], v[74:75], v[74:75], v[32:33]
    v_pk_fma_f32 v[36:37], v[154:155], v[154:155], v[36:37]
    v_pk_fma_f32 v[30:31], v[76:77], v[76:77], v[30:31]
    v_pk_fma_f32 v[34:35], v[156:157], v[156:157], v[34:35]
    v_pk_fma_f32 v[32:33], v[78:79], v[78:79], v[32:33]
    buffer_load_dwordx4 v46, s[36:39], s3 offen offset:0 lds
    s_add_u32 m0, s14, 4096
    s_add_u32 s3, s73, s65
    s_cmp_eq_u32 s74, 7
    s_cselect_b64 s[0:1], 15, 0
    v_pk_fma_f32 v[36:37], v[158:159], v[158:159], v[36:37]
    s_waitcnt vmcnt(8)
fnet_kernel_stg55:
    ds_read_b64_tr_b16 v[224:225], v22 offset:6144
    ds_read_b64_tr_b16 v[226:227], v22 offset:6400
    ds_read_b64_tr_b16 v[228:229], v22 offset:7168
    ds_read_b64_tr_b16 v[230:231], v22 offset:7424
    ds_read_b64_tr_b16 v[232:233], v23 offset:6144
    ds_read_b64_tr_b16 v[234:235], v23 offset:6400
    ds_read_b64_tr_b16 v[236:237], v23 offset:7168
    ds_read_b64_tr_b16 v[238:239], v23 offset:7424
    v_pk_add_f32 v[26:27], v[80:81], v[82:83]
    v_pk_add_f32 v[28:29], v[84:85], v[86:87]
    v_pk_add_f32 v[26:27], v[26:27], v[88:89]
    v_pk_add_f32 v[28:29], v[28:29], v[90:91]
    v_pk_add_f32 v[26:27], v[26:27], v[92:93]
    v_pk_add_f32 v[28:29], v[28:29], v[94:95]
    v_pk_add_f32 v[26:27], v[26:27], v[28:29]
    v_add_f32 v26, v26, v27
    s_cbranch_vccnz fnet_kernel_rty59
fnet_kernel_cont63:
    buffer_load_dwordx4 v43, s[36:39], s3 offen offset:1024 lds
    v_cndmask_b32 v46, v42, v47, s[0:1]
    v_add_f32 v24, v24, v26
    v_pk_add_f32 v[160:161], v[160:161], v[80:81]
    v_cndmask_b32 v39, v80, v96, s[8:9]
    v_sub_f32 v26, v39, v80
    v_mov_b32 v80, v39
    v_add_f32 v38, v38, v26
    buffer_load_dwordx4 v44, s[36:39], s3 offen offset:2048 lds
    v_pk_add_f32 v[162:163], v[162:163], v[82:83]
    v_pk_add_f32 v[164:165], v[164:165], v[84:85]
    v_pk_add_f32 v[166:167], v[166:167], v[86:87]
    s_waitcnt lgkmcnt(4)
    v_mfma_f32_32x32x16_bf16 v[96:111], v[224:227], v[192:195], v[112:127]
    v_bitop3_b32 v26, v224, v225, s41 bitop3:0x7e
    buffer_load_dwordx4 v45, s[36:39], s3 offen offset:3072 lds
    v_bitop3_b32 v27, v226, v227, s41 bitop3:0x7e
    v_pk_add_f32 v[168:169], v[168:169], v[88:89]
    v_pk_add_f32 v[170:171], v[170:171], v[90:91]
    v_pk_add_f32 v[172:173], v[172:173], v[92:93]
    v_pk_add_f32 v[174:175], v[174:175], v[94:95]
    v_mfma_f32_32x32x16_bf16 v[96:111], v[228:231], v[196:199], v[96:111]
    v_bitop3_b32 v28, v228, v229, s41 bitop3:0x7e
    v_bitop3_b32 v29, v230, v231, s41 bitop3:0x7e
    v_or3_b32 v26, v26, v27, v28
    v_pk_fma_f32 v[30:31], v[80:81], v[80:81], v[30:31]
    v_pk_fma_f32 v[34:35], v[160:161], v[160:161], v[34:35]
    v_pk_fma_f32 v[32:33], v[82:83], v[82:83], v[32:33]
    buffer_load_dwordx4 v46, s[36:39], s3 offen offset:0 lds
    s_add_u32 m0, s14, 8192
    s_add_u32 s3, s73, s65
    s_cmp_eq_u32 s74, 0
    s_cselect_b64 s[0:1], 15, 0
    v_pk_fma_f32 v[36:37], v[162:163], v[162:163], v[36:37]
    s_waitcnt lgkmcnt(0)
    v_mfma_f32_32x32x16_bf16 v[96:111], v[232:235], v[200:203], v[96:111]
    v_bitop3_b32 v27, v232, v233, s41 bitop3:0x7e
    v_bitop3_b32 v28, v234, v235, s41 bitop3:0x7e
    v_or3_b32 v26, v26, v29, v27
    v_bitop3_b32 v27, v236, v237, s41 bitop3:0x7e
    v_pk_fma_f32 v[30:31], v[84:85], v[84:85], v[30:31]
    v_pk_fma_f32 v[34:35], v[164:165], v[164:165], v[34:35]
    buffer_load_dwordx4 v49, s[36:39], s3 offen offset:1024 lds
    v_cndmask_b32 v46, v48, v47, s[0:1]
    v_pk_fma_f32 v[32:33], v[86:87], v[86:87], v[32:33]
    v_pk_fma_f32 v[36:37], v[166:167], v[166:167], v[36:37]
    v_mfma_f32_32x32x16_bf16 v[96:111], v[236:239], v[204:207], v[96:111]
    v_bitop3_b32 v29, v238, v239, s41 bitop3:0x7e
    v_or3_b32 v26, v26, v27, v28
    v_bitop3_b32 v26, v26, v29, s48 bitop3:0xa8
    v_cmp_ne_u32 vcc, 0, v26
    v_pk_fma_f32 v[30:31], v[88:89], v[88:89], v[30:31]
    v_pk_fma_f32 v[34:35], v[168:169], v[168:169], v[34:35]
    v_pk_fma_f32 v[32:33], v[90:91], v[90:91], v[32:33]
    v_pk_fma_f32 v[36:37], v[170:171], v[170:171], v[36:37]
    v_pk_fma_f32 v[30:31], v[92:93], v[92:93], v[30:31]
    buffer_load_dwordx4 v50, s[36:39], s3 offen offset:2048 lds
    v_pk_fma_f32 v[34:35], v[172:173], v[172:173], v[34:35]
    v_pk_fma_f32 v[32:33], v[94:95], v[94:95], v[32:33]
    v_pk_fma_f32 v[36:37], v[174:175], v[174:175], v[36:37]
fnet_kernel_stg56:
    v_pk_add_f32 v[26:27], v[96:97], v[98:99]
    v_pk_add_f32 v[28:29], v[100:101], v[102:103]
    v_pk_add_f32 v[26:27], v[26:27], v[104:105]
    v_pk_add_f32 v[28:29], v[28:29], v[106:107]
    v_pk_add_f32 v[26:27], v[26:27], v[108:109]
    v_pk_add_f32 v[28:29], v[28:29], v[110:111]
    v_pk_add_f32 v[26:27], v[26:27], v[28:29]
    v_add_f32 v26, v26, v27
    s_cbranch_vccnz fnet_kernel_rty60
fnet_kernel_cont64:
    buffer_load_dwordx4 v51, s[36:39], s3 offen offset:3072 lds
    v_add_f32 v24, v24, v26
    v_pk_add_f32 v[176:177], v[176:177], v[96:97]
    v_pk_add_f32 v[178:179], v[178:179], v[98:99]
    v_pk_add_f32 v[180:181], v[180:181], v[100:101]
    v_pk_add_f32 v[182:183], v[182:183], v[102:103]
    v_pk_add_f32 v[184:185], v[184:185], v[104:105]
    v_pk_add_f32 v[186:187], v[186:187], v[106:107]
    v_pk_add_f32 v[188:189], v[188:189], v[108:109]
    v_pk_add_f32 v[190:191], v[190:191], v[110:111]
    v_pk_fma_f32 v[30:31], v[96:97], v[96:97], v[30:31]
    v_pk_fma_f32 v[34:35], v[176:177], v[176:177], v[34:35]
    v_pk_fma_f32 v[32:33], v[98:99], v[98:99], v[32:33]
    v_pk_fma_f32 v[36:37], v[178:179], v[178:179], v[36:37]
    v_pk_fma_f32 v[30:31], v[100:101], v[100:101], v[30:31]
    v_pk_fma_f32 v[34:35], v[180:181], v[180:181], v[34:35]
    v_pk_fma_f32 v[32:33], v[102:103], v[102:103], v[32:33]
    buffer_load_dwordx4 v46, s[36:39], s3 offen offset:0 lds
    s_lshr_b32 s3, s2, 3
    s_lshl2_add_u32 s3, s3, s22
    s_mul_i32 s3, s3, 14336
    s_and_b32 s0, s18, 512
    s_add_u32 s3, s3, s0
    v_pk_fma_f32 v[36:37], v[182:183], v[182:183], v[36:37]
    v_pk_fma_f32 v[30:31], v[104:105], v[104:105], v[30:31]
    v_pk_fma_f32 v[34:35], v[184:185], v[184:185], v[34:35]
    v_pk_fma_f32 v[32:33], v[106:107], v[106:107], v[32:33]
    v_pk_fma_f32 v[36:37], v[186:187], v[186:187], v[36:37]
    v_pk_fma_f32 v[30:31], v[108:109], v[108:109], v[30:31]
    v_pk_fma_f32 v[34:35], v[188:189], v[188:189], v[34:35]
    v_pk_fma_f32 v[32:33], v[110:111], v[110:111], v[32:33]
    buffer_load_dword v63, v63, s[28:31], s3 offen
    s_add_u32 m0, s14, 12288
    s_add_u32 s3, s72, s65
    s_cmp_eq_u32 s74, 1
    s_cselect_b64 s[0:1], 15, 0
    v_pk_fma_f32 v[36:37], v[190:191], v[190:191], v[36:37]
    v_pk_add_f32 v[30:31], v[30:31], v[32:33]
    v_pk_add_f32 v[34:35], v[34:35], v[36:37]
    v_add_f32 v31, v30, v31
    v_add_f32 v33, v34, v35
    v_add_f32 v30, v24, v38
    v_mov_b32 v32, v24
    s_mov_b32 s16, 0x3b000000
    v_mov_b32 v39, 0x3727c5ac
    v_permlane32_swap_b32 v31, v33
    v_permlane32_swap_b32 v30, v32
    v_pk_add_f32 v[30:31], v[30:31], v[32:33]
    ds_write_b64 v6, v[30:31]
    s_waitcnt lgkmcnt(0)
    s_barrier
    ds_read_b128 v[28:31], v16
    ds_read_b128 v[32:35], v16 offset:16
    s_waitcnt lgkmcnt(0)
    v_pk_add_f32 v[28:29], v[28:29], v[30:31]
    v_pk_add_f32 v[32:33], v[32:33], v[34:35]
    v_pk_add_f32 v[28:29], v[28:29], v[32:33]
    v_add_f32 v28, v28, v25
    v_mul_f32 v27, s16, v28
    v_fma_f32 v29, v29, s16, v39
    v_fma_f32 v29, -v27, v27, v29
    v_max_f32 v29, v29, v39
    v_rsq_f32 v30, v29
    s_nop 0
    v_mul_f32 v31, -v27, v30
    v_mov_b32 v32, v30
    v_mul_f32 v26, v29, v30
    v_mov_b32 v33, v31
    v_permlane32_swap_b32 v30, v32
    ds_write_b64 v17, v[26:27] offset:512
    v_permlane32_swap_b32 v31, v33
    v_pk_fma_f32 v[208:209], v[208:209], v[30:31], v[30:31] op_sel:[0,0,1] op_sel_hi:[1,0,1]
    v_pk_fma_f32 v[210:211], v[210:211], v[30:31], v[30:31] op_sel:[0,0,1] op_sel_hi:[1,0,1]
    v_pk_fma_f32 v[212:213], v[212:213], v[30:31], v[30:31] op_sel:[0,0,1] op_sel_hi:[1,0,1]
    v_pk_fma_f32 v[214:215], v[214:215], v[30:31], v[30:31] op_sel:[0,0,1] op_sel_hi:[1,0,1]
    v_cvt_pk_bf16_f32 v224, v208, v209
    v_cvt_pk_bf16_f32 v225, v210, v211
    v_cvt_pk_bf16_f32 v226, v212, v213
    v_cvt_pk_bf16_f32 v227, v214, v215
    ds_write_b128 v20, v[224:227] offset:0
    v_pk_fma_f32 v[128:129], v[128:129], v[32:33], v[32:33] op_sel:[0,0,1] op_sel_hi:[1,0,1]
    v_pk_fma_f32 v[130:131], v[130:131], v[32:33], v[32:33] op_sel:[0,0,1] op_sel_hi:[1,0,1]
    v_pk_fma_f32 v[132:133], v[132:133], v[32:33], v[32:33] op_sel:[0,0,1] op_sel_hi:[1,0,1]
    v_pk_fma_f32 v[134:135], v[134:135], v[32:33], v[32:33] op_sel:[0,0,1] op_sel_hi:[1,0,1]
    v_cvt_pk_bf16_f32 v228, v128, v129
    v_cvt_pk_bf16_f32 v229, v130, v131
    v_cvt_pk_bf16_f32 v230, v132, v133
    v_cvt_pk_bf16_f32 v231, v134, v135
    ds_write_b128 v18, v[228:231] offset:0
    v_pk_fma_f32 v[216:217], v[216:217], v[30:31], v[30:31] op_sel:[0,0,1] op_sel_hi:[1,0,1]
    v_pk_fma_f32 v[218:219], v[218:219], v[30:31], v[30:31] op_sel:[0,0,1] op_sel_hi:[1,0,1]
    v_pk_fma_f32 v[220:221], v[220:221], v[30:31], v[30:31] op_sel:[0,0,1] op_sel_hi:[1,0,1]
    v_pk_fma_f32 v[222:223], v[222:223], v[30:31], v[30:31] op_sel:[0,0,1] op_sel_hi:[1,0,1]
    v_cvt_pk_bf16_f32 v232, v216, v217
    v_cvt_pk_bf16_f32 v233, v218, v219
    v_cvt_pk_bf16_f32 v234, v220, v221
    v_cvt_pk_bf16_f32 v235, v222, v223
    ds_write_b128 v21, v[232:235] offset:0
    v_pk_fma_f32 v[136:137], v[136:137], v[32:33], v[32:33] op_sel:[0,0,1] op_sel_hi:[1,0,1]
    v_pk_fma_f32 v[138:139], v[138:139], v[32:33], v[32:33] op_sel:[0,0,1] op_sel_hi:[1,0,1]
    v_pk_fma_f32 v[140:141], v[140:141], v[32:33], v[32:33] op_sel:[0,0,1] op_sel_hi:[1,0,1]
    v_pk_fma_f32 v[142:143], v[142:143], v[32:33], v[32:33] op_sel:[0,0,1] op_sel_hi:[1,0,1]
    v_cvt_pk_bf16_f32 v236, v136, v137
    v_cvt_pk_bf16_f32 v237, v138, v139
    v_cvt_pk_bf16_f32 v238, v140, v141
    v_cvt_pk_bf16_f32 v239, v142, v143
    ds_write_b128 v19, v[236:239] offset:0
    v_pk_fma_f32 v[64:65], v[64:65], v[30:31], v[30:31] op_sel:[0,0,1] op_sel_hi:[1,0,1]
    v_pk_fma_f32 v[66:67], v[66:67], v[30:31], v[30:31] op_sel:[0,0,1] op_sel_hi:[1,0,1]
    v_pk_fma_f32 v[68:69], v[68:69], v[30:31], v[30:31] op_sel:[0,0,1] op_sel_hi:[1,0,1]
    v_pk_fma_f32 v[70:71], v[70:71], v[30:31], v[30:31] op_sel:[0,0,1] op_sel_hi:[1,0,1]
    v_cvt_pk_bf16_f32 v224, v64, v65
    v_cvt_pk_bf16_f32 v225, v66, v67
    v_cvt_pk_bf16_f32 v226, v68, v69
    v_cvt_pk_bf16_f32 v227, v70, v71
    ds_write_b128 v20, v[224:227] offset:2048
    v_pk_fma_f32 v[144:145], v[144:145], v[32:33], v[32:33] op_sel:[0,0,1] op_sel_hi:[1,0,1]
    v_pk_fma_f32 v[146:147], v[146:147], v[32:33], v[32:33] op_sel:[0,0,1] op_sel_hi:[1,0,1]
    v_pk_fma_f32 v[148:149], v[148:149], v[32:33], v[32:33] op_sel:[0,0,1] op_sel_hi:[1,0,1]
    v_pk_fma_f32 v[150:151], v[150:151], v[32:33], v[32:33] op_sel:[0,0,1] op_sel_hi:[1,0,1]
    v_cvt_pk_bf16_f32 v228, v144, v145
    v_cvt_pk_bf16_f32 v229, v146, v147
    v_cvt_pk_bf16_f32 v230, v148, v149
    v_cvt_pk_bf16_f32 v231, v150, v151
    ds_write_b128 v18, v[228:231] offset:2048
    v_pk_fma_f32 v[72:73], v[72:73], v[30:31], v[30:31] op_sel:[0,0,1] op_sel_hi:[1,0,1]
    v_pk_fma_f32 v[74:75], v[74:75], v[30:31], v[30:31] op_sel:[0,0,1] op_sel_hi:[1,0,1]
    v_pk_fma_f32 v[76:77], v[76:77], v[30:31], v[30:31] op_sel:[0,0,1] op_sel_hi:[1,0,1]
    v_pk_fma_f32 v[78:79], v[78:79], v[30:31], v[30:31] op_sel:[0,0,1] op_sel_hi:[1,0,1]
    v_cvt_pk_bf16_f32 v232, v72, v73
    v_cvt_pk_bf16_f32 v233, v74, v75
    v_cvt_pk_bf16_f32 v234, v76, v77
    v_cvt_pk_bf16_f32 v235, v78, v79
    ds_write_b128 v21, v[232:235] offset:2048
    v_pk_fma_f32 v[152:153], v[152:153], v[32:33], v[32:33] op_sel:[0,0,1] op_sel_hi:[1,0,1]
    v_pk_fma_f32 v[154:155], v[154:155], v[32:33], v[32:33] op_sel:[0,0,1] op_sel_hi:[1,0,1]
    v_pk_fma_f32 v[156:157], v[156:157], v[32:33], v[32:33] op_sel:[0,0,1] op_sel_hi:[1,0,1]
    v_pk_fma_f32 v[158:159], v[158:159], v[32:33], v[32:33] op_sel:[0,0,1] op_sel_hi:[1,0,1]
    v_cvt_pk_bf16_f32 v236, v152, v153
    v_cvt_pk_bf16_f32 v237, v154, v155
    v_cvt_pk_bf16_f32 v238, v156, v157
    v_cvt_pk_bf16_f32 v239, v158, v159
    ds_write_b128 v19, v[236:239] offset:2048
    v_pk_fma_f32 v[80:81], v[80:81], v[30:31], v[30:31] op_sel:[0,0,1] op_sel_hi:[1,0,1]
    v_pk_fma_f32 v[82:83], v[82:83], v[30:31], v[30:31] op_sel:[0,0,1] op_sel_hi:[1,0,1]
    v_pk_fma_f32 v[84:85], v[84:85], v[30:31], v[30:31] op_sel:[0,0,1] op_sel_hi:[1,0,1]
    v_pk_fma_f32 v[86:87], v[86:87], v[30:31], v[30:31] op_sel:[0,0,1] op_sel_hi:[1,0,1]
    v_cvt_pk_bf16_f32 v224, v80, v81
    v_cvt_pk_bf16_f32 v225, v82, v83
    v_cvt_pk_bf16_f32 v226, v84, v85
    v_cvt_pk_bf16_f32 v227, v86, v87
    ds_write_b128 v20, v[224:227] offset:4096
    v_pk_fma_f32 v[160:161], v[160:161], v[32:33], v[32:33] op_sel:[0,0,1] op_sel_hi:[1,0,1]
    v_pk_fma_f32 v[162:163], v[162:163], v[32:33], v[32:33] op_sel:[0,0,1] op_sel_hi:[1,0,1]
    v_pk_fma_f32 v[164:165], v[164:165], v[32:33], v[32:33] op_sel:[0,0,1] op_sel_hi:[1,0,1]
    v_pk_fma_f32 v[166:167], v[166:167], v[32:33], v[32:33] op_sel:[0,0,1] op_sel_hi:[1,0,1]
    v_cvt_pk_bf16_f32 v228, v160, v161
    v_cvt_pk_bf16_f32 v229, v162, v163
    v_cvt_pk_bf16_f32 v230, v164, v165
    v_cvt_pk_bf16_f32 v231, v166, v167
    ds_write_b128 v18, v[228:231] offset:4096
    v_pk_fma_f32 v[88:89], v[88:89], v[30:31], v[30:31] op_sel:[0,0,1] op_sel_hi:[1,0,1]
    v_pk_fma_f32 v[90:91], v[90:91], v[30:31], v[30:31] op_sel:[0,0,1] op_sel_hi:[1,0,1]
    v_pk_fma_f32 v[92:93], v[92:93], v[30:31], v[30:31] op_sel:[0,0,1] op_sel_hi:[1,0,1]
    v_pk_fma_f32 v[94:95], v[94:95], v[30:31], v[30:31] op_sel:[0,0,1] op_sel_hi:[1,0,1]
    v_cvt_pk_bf16_f32 v232, v88, v89
    v_cvt_pk_bf16_f32 v233, v90, v91
    v_cvt_pk_bf16_f32 v234, v92, v93
    v_cvt_pk_bf16_f32 v235, v94, v95
    ds_write_b128 v21, v[232:235] offset:4096
    v_pk_fma_f32 v[168:169], v[168:169], v[32:33], v[32:33] op_sel:[0,0,1] op_sel_hi:[1,0,1]
    v_pk_fma_f32 v[170:171], v[170:171], v[32:33], v[32:33] op_sel:[0,0,1] op_sel_hi:[1,0,1]
    v_pk_fma_f32 v[172:173], v[172:173], v[32:33], v[32:33] op_sel:[0,0,1] op_sel_hi:[1,0,1]
    v_pk_fma_f32 v[174:175], v[174:175], v[32:33], v[32:33] op_sel:[0,0,1] op_sel_hi:[1,0,1]
    v_cvt_pk_bf16_f32 v236, v168, v169
    v_cvt_pk_bf16_f32 v237, v170, v171
    v_cvt_pk_bf16_f32 v238, v172, v173
    v_cvt_pk_bf16_f32 v239, v174, v175
    ds_write_b128 v19, v[236:239] offset:4096
    v_pk_fma_f32 v[96:97], v[96:97], v[30:31], v[30:31] op_sel:[0,0,1] op_sel_hi:[1,0,1]
    v_pk_fma_f32 v[98:99], v[98:99], v[30:31], v[30:31] op_sel:[0,0,1] op_sel_hi:[1,0,1]
    v_pk_fma_f32 v[100:101], v[100:101], v[30:31], v[30:31] op_sel:[0,0,1] op_sel_hi:[1,0,1]
    v_pk_fma_f32 v[102:103], v[102:103], v[30:31], v[30:31] op_sel:[0,0,1] op_sel_hi:[1,0,1]
    v_cvt_pk_bf16_f32 v224, v96, v97
    v_cvt_pk_bf16_f32 v225, v98, v99
    v_cvt_pk_bf16_f32 v226, v100, v101
    v_cvt_pk_bf16_f32 v227, v102, v103
    ds_write_b128 v20, v[224:227] offset:6144
    v_pk_fma_f32 v[176:177], v[176:177], v[32:33], v[32:33] op_sel:[0,0,1] op_sel_hi:[1,0,1]
    v_pk_fma_f32 v[178:179], v[178:179], v[32:33], v[32:33] op_sel:[0,0,1] op_sel_hi:[1,0,1]
    v_pk_fma_f32 v[180:181], v[180:181], v[32:33], v[32:33] op_sel:[0,0,1] op_sel_hi:[1,0,1]
    v_pk_fma_f32 v[182:183], v[182:183], v[32:33], v[32:33] op_sel:[0,0,1] op_sel_hi:[1,0,1]
    v_cvt_pk_bf16_f32 v228, v176, v177
    v_cvt_pk_bf16_f32 v229, v178, v179
    v_cvt_pk_bf16_f32 v230, v180, v181
    v_cvt_pk_bf16_f32 v231, v182, v183
    ds_write_b128 v18, v[228:231] offset:6144
    v_pk_fma_f32 v[104:105], v[104:105], v[30:31], v[30:31] op_sel:[0,0,1] op_sel_hi:[1,0,1]
    v_pk_fma_f32 v[106:107], v[106:107], v[30:31], v[30:31] op_sel:[0,0,1] op_sel_hi:[1,0,1]
    v_pk_fma_f32 v[108:109], v[108:109], v[30:31], v[30:31] op_sel:[0,0,1] op_sel_hi:[1,0,1]
    v_pk_fma_f32 v[110:111], v[110:111], v[30:31], v[30:31] op_sel:[0,0,1] op_sel_hi:[1,0,1]
    v_cvt_pk_bf16_f32 v232, v104, v105
    v_cvt_pk_bf16_f32 v233, v106, v107
    v_cvt_pk_bf16_f32 v234, v108, v109
    v_cvt_pk_bf16_f32 v235, v110, v111
    ds_write_b128 v21, v[232:235] offset:6144
    v_pk_fma_f32 v[184:185], v[184:185], v[32:33], v[32:33] op_sel:[0,0,1] op_sel_hi:[1,0,1]
    v_pk_fma_f32 v[186:187], v[186:187], v[32:33], v[32:33] op_sel:[0,0,1] op_sel_hi:[1,0,1]
    v_pk_fma_f32 v[188:189], v[188:189], v[32:33], v[32:33] op_sel:[0,0,1] op_sel_hi:[1,0,1]
    v_pk_fma_f32 v[190:191], v[190:191], v[32:33], v[32:33] op_sel:[0,0,1] op_sel_hi:[1,0,1]
    v_cvt_pk_bf16_f32 v236, v184, v185
    v_cvt_pk_bf16_f32 v237, v186, v187
    v_cvt_pk_bf16_f32 v238, v188, v189
    v_cvt_pk_bf16_f32 v239, v190, v191
    ds_write_b128 v19, v[236:239] offset:6144
    s_waitcnt lgkmcnt(0)
    s_barrier
    ds_read_b128 v[64:67], v10 offset:0
    ds_read_b128 v[68:71], v11 offset:0
    buffer_load_dwordx4 v49, s[36:39], s3 offen offset:1024 lds
    v_cndmask_b32 v46, v48, v47, s[0:1]
    v_xor_b32 v40, s19, v40
    ds_read_b128 v[72:75], v12 offset:0
    ds_read_b128 v[76:79], v13 offset:0
    buffer_load_dwordx4 v50, s[36:39], s3 offen offset:2048 lds
    v_xor_b32 v41, s19, v41
    s_waitcnt vmcnt(15)
    ds_read_b128 v[80:83], v10 offset:2048
    buffer_load_dwordx4 v51, s[36:39], s3 offen offset:3072 lds
    ds_read_b128 v[84:87], v11 offset:2048
    ds_read_b128 v[88:91], v12 offset:2048
    buffer_load_dwordx4 v46, s[36:39], s3 offen offset:0 lds
    ds_read_b128 v[92:95], v13 offset:2048
    ds_read_b128 v[96:99], v10 offset:4096
    s_waitcnt lgkmcnt(7)
    v_mfma_f32_16x16x32_bf16 v[144:147], a[0:3], v[64:67], v[240:243]
    ds_read_b128 v[100:103], v11 offset:4096
    v_mfma_f32_16x16x32_bf16 v[148:151], a[4:7], v[64:67], v[244:247]
    v_mfma_f32_16x16x32_bf16 v[152:155], a[0:3], v[68:71], v[240:243]
    ds_read_b128 v[104:107], v12 offset:4096
    v_mfma_f32_16x16x32_bf16 v[156:159], a[4:7], v[68:71], v[244:247]
    s_waitcnt lgkmcnt(7)
    ds_read_b128 v[108:111], v13 offset:4096
    v_mfma_f32_16x16x32_bf16 v[160:163], a[0:3], v[72:75], v[240:243]
    ds_read_b128 v[64:67], v10 offset:6144
    ds_read_b64_tr_b16 a[144:145], v40 offset:16384
    v_mfma_f32_16x16x32_bf16 v[164:167], a[4:7], v[72:75], v[244:247]
    ds_read_b128 v[68:71], v11 offset:6144
    v_mfma_f32_16x16x32_bf16 v[168:171], a[0:3], v[76:79], v[240:243]
    ds_read_b64_tr_b16 a[146:147], v40 offset:16640
    v_mfma_f32_16x16x32_bf16 v[172:175], a[4:7], v[76:79], v[244:247]
    s_waitcnt lgkmcnt(10)
    ds_read_b128 v[72:75], v12 offset:6144
    v_mfma_f32_16x16x32_bf16 v[144:147], a[8:11], v[80:83], v[144:147]
    ds_read_b128 v[76:79], v13 offset:6144
    v_mfma_f32_16x16x32_bf16 v[148:151], a[12:15], v[80:83], v[148:151]
    ds_read_b64_tr_b16 a[148:149], v41 offset:16384
    v_mfma_f32_16x16x32_bf16 v[152:155], a[8:11], v[84:87], v[152:155]
    ds_read_b64_tr_b16 a[150:151], v41 offset:16640
    ds_read_b64_tr_b16 a[152:153], v40 offset:18432
    v_mfma_f32_16x16x32_bf16 v[156:159], a[12:15], v[84:87], v[156:159]
    s_waitcnt lgkmcnt(12)
    ds_read_b128 v[80:83], v10 offset:8192
    v_mfma_f32_16x16x32_bf16 v[160:163], a[8:11], v[88:91], v[160:163]
    ds_read_b128 v[84:87], v11 offset:8192
    v_mfma_f32_16x16x32_bf16 v[164:167], a[12:15], v[88:91], v[164:167]
    ds_read_b64_tr_b16 a[154:155], v40 offset:18688
    v_mfma_f32_16x16x32_bf16 v[168:171], a[8:11], v[92:95], v[168:171]
    ds_read_b64_tr_b16 a[156:157], v41 offset:18432
    ds_read_b64_tr_b16 a[158:159], v41 offset:18688
    v_mfma_f32_16x16x32_bf16 v[172:175], a[12:15], v[92:95], v[172:175]
    s_waitcnt lgkmcnt(14)
    ds_read_b128 v[88:91], v12 offset:8192
    s_waitcnt vmcnt(13)
    v_mfma_f32_16x16x32_bf16 v[144:147], a[16:19], v[96:99], v[144:147]
    ds_read_b128 v[92:95], v13 offset:8192
    v_mfma_f32_16x16x32_bf16 v[148:151], a[20:23], v[96:99], v[148:151]
    ds_read_b64_tr_b16 a[160:161], v40 offset:0
    v_mfma_f32_16x16x32_bf16 v[152:155], a[16:19], v[100:103], v[152:155]
    ds_read_b64_tr_b16 a[162:163], v40 offset:256
    ds_read_b64_tr_b16 a[164:165], v41 offset:0
    v_mfma_f32_16x16x32_bf16 v[156:159], a[20:23], v[100:103], v[156:159]
    ds_read_b128 v[96:99], v10 offset:10240
    v_mfma_f32_16x16x32_bf16 v[160:163], a[16:19], v[104:107], v[160:163]
    ds_read_b128 v[100:103], v11 offset:10240
    v_mfma_f32_16x16x32_bf16 v[164:167], a[20:23], v[104:107], v[164:167]
    ds_read_b64_tr_b16 a[166:167], v41 offset:256
    v_mfma_f32_16x16x32_bf16 v[168:171], a[16:19], v[108:111], v[168:171]
    s_waitcnt lgkmcnt(8)
    ds_read_b64_tr_b16 a[168:169], v40 offset:2048
    ds_read_b64_tr_b16 a[170:171], v40 offset:2304
    v_mfma_f32_16x16x32_bf16 v[172:175], a[20:23], v[108:111], v[172:175]
    s_add_u32 m0, s14, 16384
    ds_read_b128 v[104:107], v12 offset:10240
    s_add_u32 s3, s71, s65
    v_mfma_f32_16x16x32_bf16 v[144:147], a[24:27], v[64:67], v[144:147]
    s_cmp_eq_u32 s74, 2
    s_cselect_b64 s[0:1], 15, 0
    buffer_load_dwordx4 v49, s[36:39], s3 offen offset:1024 lds
    v_mfma_f32_16x16x32_bf16 v[148:151], a[28:31], v[64:67], v[148:151]
    ds_read_b128 v[108:111], v13 offset:10240
    ds_read_b64_tr_b16 a[172:173], v41 offset:2048
    v_mfma_f32_16x16x32_bf16 v[152:155], a[24:27], v[68:71], v[152:155]
    ds_read_b64_tr_b16 a[174:175], v41 offset:2304
    v_cndmask_b32 v46, v48, v47, s[0:1]
    v_mfma_f32_16x16x32_bf16 v[156:159], a[28:31], v[68:71], v[156:159]
    s_waitcnt vmcnt(10)
    ds_read_b128 v[64:67], v10 offset:12288
    buffer_load_dwordx4 v50, s[36:39], s3 offen offset:2048 lds
    v_mfma_f32_16x16x32_bf16 v[160:163], a[24:27], v[72:75], v[160:163]
    ds_read_b128 v[68:71], v11 offset:12288
    v_mfma_f32_16x16x32_bf16 v[164:167], a[28:31], v[72:75], v[164:167]
    ds_read_b64_tr_b16 a[176:177], v40 offset:4096
    buffer_load_dwordx4 v51, s[36:39], s3 offen offset:3072 lds
    v_mfma_f32_16x16x32_bf16 v[168:171], a[24:27], v[76:79], v[168:171]
    ds_read_b64_tr_b16 a[178:179], v40 offset:4352
    ds_read_b64_tr_b16 a[180:181], v41 offset:4096
    v_mfma_f32_16x16x32_bf16 v[172:175], a[28:31], v[76:79], v[172:175]
    ds_read_b128 v[72:75], v12 offset:12288
    buffer_load_dwordx4 v46, s[36:39], s3 offen offset:0 lds
    v_mfma_f32_16x16x32_bf16 v[144:147], a[32:35], v[80:83], v[144:147]
    ds_read_b128 v[76:79], v13 offset:12288
    v_mfma_f32_16x16x32_bf16 v[148:151], a[36:39], v[80:83], v[148:151]
    ds_read_b64_tr_b16 a[182:183], v41 offset:4352
    global_load_dwordx2 v[16:17], v0, s[56:57] offset:0
    v_mfma_f32_16x16x32_bf16 v[152:155], a[32:35], v[84:87], v[152:155]
    ds_read_b64_tr_b16 a[184:185], v40 offset:6144
    ds_read_b64_tr_b16 a[186:187], v40 offset:6400
    v_mfma_f32_16x16x32_bf16 v[156:159], a[36:39], v[84:87], v[156:159]
    s_waitcnt lgkmcnt(13)
    ds_read_b128 v[80:83], v10 offset:14336
    global_load_dwordx2 v[18:19], v0, s[56:57] offset:32
    v_mfma_f32_16x16x32_bf16 v[160:163], a[32:35], v[88:91], v[160:163]
    ds_read_b128 v[84:87], v11 offset:14336
    v_mfma_f32_16x16x32_bf16 v[164:167], a[36:39], v[88:91], v[164:167]
    ds_read_b64_tr_b16 a[188:189], v41 offset:6144
    global_load_dwordx2 v[20:21], v0, s[56:57] offset:64
    v_mfma_f32_16x16x32_bf16 v[168:171], a[32:35], v[92:95], v[168:171]
    ds_read_b64_tr_b16 a[190:191], v41 offset:6400
    s_waitcnt vmcnt(12)
    v_mfma_f32_16x16x32_bf16 v[172:175], a[36:39], v[92:95], v[172:175]
    ds_read_b128 v[88:91], v12 offset:14336
    global_load_dwordx2 v[22:23], v0, s[56:57] offset:96
    v_mfma_f32_16x16x32_bf16 v[144:147], a[40:43], v[96:99], v[144:147]
    s_waitcnt lgkmcnt(12)
    ds_read_b128 v[92:95], v13 offset:14336
    s_add_u32 m0, s14, 0
    v_mfma_f32_16x16x32_bf16 v[148:151], a[44:47], v[96:99], v[148:151]
    s_add_u32 s3, s70, s65
    ds_read_b64_tr_b16 a[192:193], v40 offset:8192
    ds_read_b64_tr_b16 a[194:195], v40 offset:8448
    v_mfma_f32_16x16x32_bf16 v[152:155], a[40:43], v[100:103], v[152:155]
    s_cmp_eq_u32 s74, 3
    s_cselect_b64 s[0:1], 15, 0
    buffer_load_dwordx4 v49, s[36:39], s3 offen offset:1024 lds
    v_mfma_f32_16x16x32_bf16 v[156:159], a[44:47], v[100:103], v[156:159]
    ds_read_b128 v[96:99], v10 offset:16384
    ds_read_b128 v[100:103], v11 offset:16384
    v_mfma_f32_16x16x32_bf16 v[160:163], a[40:43], v[104:107], v[160:163]
    v_cndmask_b32 v46, v48, v47, s[0:1]
    v_mfma_f32_16x16x32_bf16 v[164:167], a[44:47], v[104:107], v[164:167]
    ds_read_b64_tr_b16 a[196:197], v41 offset:8192
    buffer_load_dwordx4 v50, s[36:39], s3 offen offset:2048 lds
    v_mfma_f32_16x16x32_bf16 v[168:171], a[40:43], v[108:111], v[168:171]
    ds_read_b64_tr_b16 a[198:199], v41 offset:8448
    ds_read_b64_tr_b16 a[200:201], v40 offset:10240
    v_mfma_f32_16x16x32_bf16 v[172:175], a[44:47], v[108:111], v[172:175]
    ds_read_b128 v[104:107], v12 offset:16384
    buffer_load_dwordx4 v51, s[36:39], s3 offen offset:3072 lds
    v_mfma_f32_16x16x32_bf16 v[144:147], a[48:51], v[64:67], v[144:147]
    ds_read_b128 v[108:111], v13 offset:16384
    v_mfma_f32_16x16x32_bf16 v[148:151], a[52:55], v[64:67], v[148:151]
    ds_read_b64_tr_b16 a[202:203], v40 offset:10496
    buffer_load_dwordx4 v46, s[36:39], s3 offen offset:0 lds
    v_mfma_f32_16x16x32_bf16 v[152:155], a[48:51], v[68:71], v[152:155]
    s_waitcnt lgkmcnt(11)
    ds_read_b64_tr_b16 a[204:205], v41 offset:10240
    ds_read_b64_tr_b16 a[206:207], v41 offset:10496
    v_mfma_f32_16x16x32_bf16 v[156:159], a[52:55], v[68:71], v[156:159]
    s_add_u32 m0, s14, 4096
    ds_read_b128 v[64:67], v10 offset:18432
    s_mov_b32 s3, s12
    v_mfma_f32_16x16x32_bf16 v[160:163], a[48:51], v[72:75], v[160:163]
    s_waitcnt vmcnt(12)
    ds_read_b128 v[68:71], v11 offset:18432
    v_mfma_f32_16x16x32_bf16 v[164:167], a[52:55], v[72:75], v[164:167]
    ds_read_b64_tr_b16 a[208:209], v40 offset:12288
    ds_read_b64_tr_b16 a[210:211], v40 offset:12544
    v_mfma_f32_16x16x32_bf16 v[168:171], a[48:51], v[76:79], v[168:171]
    ds_read_b64_tr_b16 a[212:213], v41 offset:12288
    ds_read_b64_tr_b16 a[214:215], v41 offset:12544
    v_mfma_f32_16x16x32_bf16 v[172:175], a[52:55], v[76:79], v[172:175]
    ds_read_b128 v[72:75], v12 offset:18432
    v_mfma_f32_16x16x32_bf16 v[144:147], a[56:59], v[80:83], v[144:147]
    ds_read_b128 v[76:79], v13 offset:18432
    v_mfma_f32_16x16x32_bf16 v[148:151], a[60:63], v[80:83], v[148:151]
    ds_read_b64_tr_b16 a[216:217], v40 offset:14336
    v_mfma_f32_16x16x32_bf16 v[152:155], a[56:59], v[84:87], v[152:155]
    ds_read_b64_tr_b16 a[218:219], v40 offset:14592
    ds_read_b64_tr_b16 a[220:221], v41 offset:14336
    v_mfma_f32_16x16x32_bf16 v[156:159], a[60:63], v[84:87], v[156:159]
    s_waitcnt lgkmcnt(15)
    ds_read_b128 v[80:83], v10 offset:20480
    v_mfma_f32_16x16x32_bf16 v[160:163], a[56:59], v[88:91], v[160:163]
    ds_read_b128 v[84:87], v11 offset:20480
    v_mfma_f32_16x16x32_bf16 v[164:167], a[60:63], v[88:91], v[164:167]
    ds_read_b64_tr_b16 a[222:223], v41 offset:14592
    v_mfma_f32_16x16x32_bf16 v[168:171], a[56:59], v[92:95], v[168:171]
    v_mfma_f32_16x16x32_bf16 v[172:175], a[60:63], v[92:95], v[172:175]
    ds_read_b128 v[88:91], v12 offset:20480
    buffer_load_dwordx4 v52, s[28:31], s3 offen offset:0 lds
    v_mfma_f32_16x16x32_bf16 v[144:147], a[64:67], v[96:99], v[144:147]
    ds_read_b128 v[92:95], v13 offset:20480
    v_mfma_f32_16x16x32_bf16 v[148:151], a[68:71], v[96:99], v[148:151]
    s_waitcnt vmcnt(9)
    ds_read_b64_tr_b16 a[224:225], v40 offset:16384
    buffer_load_dwordx4 v53, s[28:31], s3 offen offset:1024 lds
    v_mfma_f32_16x16x32_bf16 v[152:155], a[64:67], v[100:103], v[152:155]
    ds_read_b64_tr_b16 a[226:227], v40 offset:16640
    ds_read_b64_tr_b16 a[228:229], v41 offset:16384
    v_mfma_f32_16x16x32_bf16 v[156:159], a[68:71], v[100:103], v[156:159]
    s_waitcnt lgkmcnt(12)
    ds_read_b128 v[96:99], v10 offset:22528
    buffer_load_dwordx4 v54, s[28:31], s3 offen offset:2048 lds
    v_mfma_f32_16x16x32_bf16 v[160:163], a[64:67], v[104:107], v[160:163]
    ds_read_b128 v[100:103], v11 offset:22528
    v_mfma_f32_16x16x32_bf16 v[164:167], a[68:71], v[104:107], v[164:167]
    ds_read_b64_tr_b16 a[230:231], v41 offset:16640
    buffer_load_dwordx4 v55, s[28:31], s3 offen offset:3072 lds
    v_mfma_f32_16x16x32_bf16 v[168:171], a[64:67], v[108:111], v[168:171]
    s_add_u32 m0, s14, 8192
    ds_read_b64_tr_b16 a[232:233], v40 offset:18432
    ds_read_b64_tr_b16 a[234:235], v40 offset:18688
    v_mfma_f32_16x16x32_bf16 v[172:175], a[68:71], v[108:111], v[172:175]
    s_cmp_ge_u32 s21, 1
    s_cselect_b32 s3, 0, 10
    ds_read_b128 v[104:107], v12 offset:22528
    v_mfma_f32_16x16x32_bf16 v[144:147], a[72:75], v[64:67], v[144:147]
    s_lshl_b32 s3, s3, 15
    ds_read_b128 v[108:111], v13 offset:22528
    s_add_u32 s3, s3, s13
    v_mfma_f32_16x16x32_bf16 v[148:151], a[76:79], v[64:67], v[148:151]
    ds_read_b64_tr_b16 a[236:237], v41 offset:18432
    buffer_load_dwordx4 v52, s[28:31], s3 offen offset:0 lds
    v_mfma_f32_16x16x32_bf16 v[152:155], a[72:75], v[68:71], v[152:155]
    ds_read_b64_tr_b16 a[238:239], v41 offset:18688
    v_mfma_f32_16x16x32_bf16 v[156:159], a[76:79], v[68:71], v[156:159]
    s_waitcnt lgkmcnt(12)
    ds_read_b128 v[64:67], v10 offset:24576
    buffer_load_dwordx4 v53, s[28:31], s3 offen offset:1024 lds
    v_mfma_f32_16x16x32_bf16 v[160:163], a[72:75], v[72:75], v[160:163]
    ds_read_b128 v[68:71], v11 offset:24576
    v_mfma_f32_16x16x32_bf16 v[164:167], a[76:79], v[72:75], v[164:167]
    v_mfma_f32_16x16x32_bf16 v[168:171], a[72:75], v[76:79], v[168:171]
    v_mfma_f32_16x16x32_bf16 v[172:175], a[76:79], v[76:79], v[172:175]
    ds_read_b128 v[72:75], v12 offset:24576
    ds_read_b128 v[76:79], v13 offset:24576
    v_mfma_f32_16x16x32_bf16 v[144:147], a[80:83], v[80:83], v[144:147]
    buffer_load_dwordx4 v54, s[28:31], s3 offen offset:2048 lds
    v_mfma_f32_16x16x32_bf16 v[148:151], a[84:87], v[80:83], v[148:151]
    v_mfma_f32_16x16x32_bf16 v[152:155], a[80:83], v[84:87], v[152:155]
    v_mfma_f32_16x16x32_bf16 v[156:159], a[84:87], v[84:87], v[156:159]
    ds_read_b128 v[80:83], v10 offset:26624
    ds_read_b128 v[84:87], v11 offset:26624
    v_mfma_f32_16x16x32_bf16 v[160:163], a[80:83], v[88:91], v[160:163]
    buffer_load_dwordx4 v55, s[28:31], s3 offen offset:3072 lds
    v_mfma_f32_16x16x32_bf16 v[164:167], a[84:87], v[88:91], v[164:167]
    s_add_u32 m0, s14, 12288
    s_cmp_ge_u32 s21, 2
    s_cselect_b32 s3, 10, 14
    v_mfma_f32_16x16x32_bf16 v[168:171], a[80:83], v[92:95], v[168:171]
    s_lshl_b32 s3, s3, 15
    s_add_u32 s3, s3, s13
    v_mfma_f32_16x16x32_bf16 v[172:175], a[84:87], v[92:95], v[172:175]
    s_waitcnt lgkmcnt(5)
    ds_read_b128 v[88:91], v12 offset:26624
    ds_read_b128 v[92:95], v13 offset:26624
    v_mfma_f32_16x16x32_bf16 v[144:147], a[88:91], v[96:99], v[144:147]
    s_waitcnt vmcnt(8)
    buffer_load_dwordx4 v52, s[28:31], s3 offen offset:0 lds
    v_mfma_f32_16x16x32_bf16 v[148:151], a[92:95], v[96:99], v[148:151]
    ds_read_b64_tr_b16 a[240:241], v40 offset:0
    ds_read_b64_tr_b16 a[242:243], v40 offset:256
    v_mfma_f32_16x16x32_bf16 v[152:155], a[88:91], v[100:103], v[152:155]
    ds_read_b64_tr_b16 a[244:245], v41 offset:0
    ds_read_b64_tr_b16 a[246:247], v41 offset:256
    v_mfma_f32_16x16x32_bf16 v[156:159], a[92:95], v[100:103], v[156:159]
    ds_read_b128 v[96:99], v10 offset:28672
    v_mfma_f32_16x16x32_bf16 v[160:163], a[88:91], v[104:107], v[160:163]
    ds_read_b128 v[100:103], v11 offset:28672
    buffer_load_dwordx4 v53, s[28:31], s3 offen offset:1024 lds
    v_mfma_f32_16x16x32_bf16 v[164:167], a[92:95], v[104:107], v[164:167]
    ds_read_b64_tr_b16 a[248:249], v40 offset:2048
    v_mfma_f32_16x16x32_bf16 v[168:171], a[88:91], v[108:111], v[168:171]
    ds_read_b64_tr_b16 a[250:251], v40 offset:2304
    ds_read_b64_tr_b16 a[252:253], v41 offset:2048
    v_mfma_f32_16x16x32_bf16 v[172:175], a[92:95], v[108:111], v[172:175]
    s_waitcnt lgkmcnt(11)
    ds_read_b128 v[104:107], v12 offset:28672
    v_mfma_f32_16x16x32_bf16 v[144:147], a[96:99], v[64:67], v[144:147]
    ds_read_b128 v[108:111], v13 offset:28672
    buffer_load_dwordx4 v54, s[28:31], s3 offen offset:2048 lds
    v_mfma_f32_16x16x32_bf16 v[148:151], a[100:103], v[64:67], v[148:151]
    ds_read_b64_tr_b16 a[254:255], v41 offset:2304
    v_mfma_f32_16x16x32_bf16 v[152:155], a[96:99], v[68:71], v[152:155]
    v_mfma_f32_16x16x32_bf16 v[156:159], a[100:103], v[68:71], v[156:159]
    ds_read_b128 v[64:67], v10 offset:30720
    buffer_load_dwordx4 v55, s[28:31], s3 offen offset:3072 lds
    v_mfma_f32_16x16x32_bf16 v[160:163], a[96:99], v[72:75], v[160:163]
    s_add_u32 m0, s14, 16384
    ds_read_b128 v[68:71], v11 offset:30720
    v_mfma_f32_16x16x32_bf16 v[164:167], a[100:103], v[72:75], v[164:167]
    s_cmp_ge_u32 s21, 3
    s_cselect_b32 s3, 14, 24
    s_lshl_b32 s3, s3, 15
    v_mfma_f32_16x16x32_bf16 v[168:171], a[96:99], v[76:79], v[168:171]
    s_add_u32 s3, s3, s13
    v_mfma_f32_16x16x32_bf16 v[172:175], a[100:103], v[76:79], v[172:175]
    s_waitcnt vmcnt(8)
    ds_read_b128 v[72:75], v12 offset:30720
    buffer_load_dwordx4 v52, s[28:31], s3 offen offset:0 lds
    v_mfma_f32_16x16x32_bf16 v[144:147], a[104:107], v[80:83], v[144:147]
    ds_read_b128 v[76:79], v13 offset:30720
    v_mfma_f32_16x16x32_bf16 v[148:151], a[108:111], v[80:83], v[148:151]
    s_waitcnt lgkmcnt(8)
    ds_read_b64_tr_b16 a[0:1], v56 offset:4096
    ds_read_b64_tr_b16 a[4:5], v57 offset:4096
    v_mfma_f32_16x16x32_bf16 v[144:147], a[112:115], v[96:99], v[144:147]
    ds_read_b64_tr_b16 a[8:9], v58 offset:4096
    ds_read_b64_tr_b16 a[12:13], v59 offset:4096
    v_mfma_f32_16x16x32_bf16 v[148:151], a[116:119], v[96:99], v[148:151]
    s_waitcnt lgkmcnt(6)
    v_mfma_f32_16x16x32_bf16 v[144:147], a[120:123], v[64:67], v[144:147]
    ds_read_b64_tr_b16 a[2:3], v56 offset:6144
    buffer_load_dwordx4 v53, s[28:31], s3 offen offset:1024 lds
    v_mfma_f32_16x16x32_bf16 v[148:151], a[124:127], v[64:67], v[148:151]
    ds_read_b64_tr_b16 a[6:7], v57 offset:6144
    ds_read_b64_tr_b16 a[10:11], v58 offset:6144
    v_mfma_f32_16x16x32_bf16 v[152:155], a[104:107], v[84:87], v[152:155]
    s_nop 1
    v_mul_f32 v144, v144, |v144|
    v_mfma_f32_16x16x32_bf16 v[156:159], a[108:111], v[84:87], v[156:159]
    ds_read_b64_tr_b16 a[14:15], v59 offset:6144
    buffer_load_dwordx4 v54, s[28:31], s3 offen offset:2048 lds
    v_mfma_f32_16x16x32_bf16 v[152:155], a[112:115], v[100:103], v[152:155]
    v_xor_b32 v10, s55, v10
    v_xor_b32 v11, s55, v11
    v_mfma_f32_16x16x32_bf16 v[156:159], a[116:119], v[100:103], v[156:159]
    v_xor_b32 v12, s55, v12
    v_xor_b32 v13, s55, v13
    v_mfma_f32_16x16x32_bf16 v[152:155], a[120:123], v[68:71], v[152:155]
    ds_read_b128 v[80:83], v10 offset:0
    ds_read_b128 v[84:87], v11 offset:0
    v_mfma_f32_16x16x32_bf16 v[156:159], a[124:127], v[68:71], v[156:159]
    buffer_load_dwordx4 v55, s[28:31], s3 offen offset:3072 lds
    v_mfma_f32_16x16x32_bf16 v[160:163], a[104:107], v[88:91], v[160:163]
    s_add_u32 m0, s14, 0
    v_mul_f32 v145, v145, |v145|
    v_mul_f32 v146, v146, |v146|
    v_mfma_f32_16x16x32_bf16 v[164:167], a[108:111], v[88:91], v[164:167]
    s_cmp_ge_u32 s21, 4
    s_cselect_b32 s3, 24, 28
    v_mul_f32 v147, v147, |v147|
    v_mfma_f32_16x16x32_bf16 v[160:163], a[112:115], v[104:107], v[160:163]
    s_lshl_b32 s3, s3, 15
    v_mul_f32 v148, v148, |v148|
    v_mul_f32 v149, v149, |v149|
    v_mfma_f32_16x16x32_bf16 v[164:167], a[116:119], v[104:107], v[164:167]
    s_waitcnt lgkmcnt(5)
    v_mul_f32 v150, v150, |v150|
    v_mul_f32 v151, v151, |v151|
    s_add_u32 s3, s3, s13
    v_mfma_f32_16x16x32_bf16 v[160:163], a[120:123], v[72:75], v[160:163]
    s_waitcnt vmcnt(8)
    ds_read_b64_tr_b16 a[16:17], v56 offset:8192
    buffer_load_dwordx4 v52, s[28:31], s3 offen offset:0 lds
    v_mfma_f32_16x16x32_bf16 v[164:167], a[124:127], v[72:75], v[164:167]
    v_cvt_pk_bf16_f32 v24, v144, v145
    v_cvt_pk_bf16_f32 v25, v146, v147
    v_mfma_f32_16x16x32_bf16 v[168:171], a[104:107], v[92:95], v[168:171]
    ds_read_b64_tr_b16 a[20:21], v57 offset:8192
    buffer_load_dwordx4 v53, s[28:31], s3 offen offset:1024 lds
    v_mfma_f32_16x16x32_bf16 v[172:175], a[108:111], v[92:95], v[172:175]
    ds_read_b128 v[88:91], v12 offset:0
    ds_read_b128 v[92:95], v13 offset:0
    v_mfma_f32_16x16x32_bf16 v[168:171], a[112:115], v[108:111], v[168:171]
    v_cvt_pk_bf16_f32 v26, v148, v149
    v_cvt_pk_bf16_f32 v27, v150, v151
    v_mfma_f32_16x16x32_bf16 v[172:175], a[116:119], v[108:111], v[172:175]
    ds_read_b128 v[96:99], v10 offset:2048
    v_mfma_f32_16x16x32_bf16 v[168:171], a[120:123], v[76:79], v[168:171]
    ds_read_b128 v[100:103], v11 offset:2048
    buffer_load_dwordx4 v54, s[28:31], s3 offen offset:2048 lds
    v_mfma_f32_16x16x32_bf16 v[172:175], a[124:127], v[76:79], v[172:175]
    v_pk_max_i16 v24, v24, 0
    v_pk_max_i16 v25, v25, 0
    v_pk_max_i16 v26, v26, 0
    v_pk_max_i16 v27, v27, 0
    v_or_b32 v144, v24, v61
    v_or_b32 v145, v25, v61
    v_or_b32 v146, v26, v61
    v_or_b32 v147, v27, v61
    v_mul_f32 v152, v152, |v152|
    ds_read_b64_tr_b16 a[24:25], v58 offset:8192
    ds_read_b64_tr_b16 a[28:29], v59 offset:8192
    ds_read_b64_tr_b16 a[18:19], v56 offset:10240
    buffer_load_dwordx4 v55, s[28:31], s3 offen offset:3072 lds
    s_waitcnt lgkmcnt(8)
    s_add_u32 m0, s14, 4096
    s_cmp_ge_u32 s21, 5
    s_cselect_b32 s3, 28, 38
    s_lshl_b32 s3, s3, 15
    s_add_u32 s3, s3, s13
    ds_read_b64_tr_b16 a[22:23], v57 offset:10240
    ds_read_b64_tr_b16 a[26:27], v58 offset:10240
    ds_read_b64_tr_b16 a[30:31], v59 offset:10240
    buffer_store_dwordx4 v[144:147], v3, s[32:35], s49 offen offset:0 sc1
    v_mul_f32 v153, v153, |v153|
    v_mul_f32 v154, v154, |v154|
    v_mul_f32 v155, v155, |v155|
    s_waitcnt vmcnt(9)
    ds_read_b64_tr_b16 a[32:33], v56 offset:12288
    ds_read_b64_tr_b16 a[36:37], v57 offset:12288
    ds_read_b64_tr_b16 a[40:41], v58 offset:12288
    buffer_load_dwordx4 v52, s[28:31], s3 offen offset:0 lds
    v_mul_f32 v156, v156, |v156|
    v_mul_f32 v157, v157, |v157|
    v_mul_f32 v158, v158, |v158|
    v_mul_f32 v159, v159, |v159|
    v_cvt_pk_bf16_f32 v28, v152, v153
    v_cvt_pk_bf16_f32 v29, v154, v155
    v_cvt_pk_bf16_f32 v30, v156, v157
    ds_read_b64_tr_b16 a[44:45], v59 offset:12288
    ds_read_b64_tr_b16 a[34:35], v56 offset:14336
    ds_read_b64_tr_b16 a[38:39], v57 offset:14336
    buffer_load_dwordx4 v53, s[28:31], s3 offen offset:1024 lds
    v_cvt_pk_bf16_f32 v31, v158, v159
    v_pk_max_i16 v28, v28, 0
    v_pk_max_i16 v29, v29, 0
    v_pk_max_i16 v30, v30, 0
    v_pk_max_i16 v31, v31, 0
    v_or_b32 v152, v28, v61
    v_or_b32 v153, v29, v61
    ds_read_b64_tr_b16 a[42:43], v58 offset:14336
    ds_read_b64_tr_b16 a[46:47], v59 offset:14336
    buffer_load_dwordx4 v54, s[28:31], s3 offen offset:2048 lds
    v_or_b32 v154, v30, v61
    v_or_b32 v155, v31, v61
    v_mul_f32 v160, v160, |v160|
    v_mul_f32 v161, v161, |v161|
    v_mul_f32 v162, v162, |v162|
    v_mul_f32 v163, v163, |v163|
    v_mul_f32 v164, v164, |v164|
    buffer_load_dwordx4 v55, s[28:31], s3 offen offset:3072 lds
    s_waitcnt lgkmcnt(7)
    s_add_u32 m0, s14, 8192
    s_cmp_ge_u32 s21, 6
    s_cselect_b32 s3, 38, 42
    s_lshl_b32 s3, s3, 15
    s_add_u32 s3, s3, s13
    buffer_store_dwordx4 v[152:155], v3, s[32:35], s49 offen offset:1024 sc1
    v_mul_f32 v165, v165, |v165|
    v_mul_f32 v166, v166, |v166|
    v_mul_f32 v167, v167, |v167|
    s_waitcnt vmcnt(10)
    ds_read_b64_tr_b16 a[48:49], v56 offset:16384
    ds_read_b64_tr_b16 a[52:53], v57 offset:16384
    ds_read_b64_tr_b16 a[56:57], v58 offset:16384
    buffer_load_dwordx4 v52, s[28:31], s3 offen offset:0 lds
    v_cvt_pk_bf16_f32 v32, v160, v161
    v_cvt_pk_bf16_f32 v33, v162, v163
    v_cvt_pk_bf16_f32 v34, v164, v165
    v_cvt_pk_bf16_f32 v35, v166, v167
    v_pk_max_i16 v32, v32, 0
    v_pk_max_i16 v33, v33, 0
    v_pk_max_i16 v34, v34, 0
    ds_read_b64_tr_b16 a[60:61], v59 offset:16384
    ds_read_b64_tr_b16 a[50:51], v56 offset:18432
    ds_read_b64_tr_b16 a[54:55], v57 offset:18432
    buffer_load_dwordx4 v53, s[28:31], s3 offen offset:1024 lds
    v_pk_max_i16 v35, v35, 0
    v_or_b32 v160, v32, v61
    v_or_b32 v161, v33, v61
    v_or_b32 v162, v34, v61
    v_or_b32 v163, v35, v61
    v_mul_f32 v168, v168, |v168|
    v_mul_f32 v169, v169, |v169|
    v_mul_f32 v170, v170, |v170|
    ds_read_b64_tr_b16 a[58:59], v58 offset:18432
    ds_read_b64_tr_b16 a[62:63], v59 offset:18432
    buffer_load_dwordx4 v54, s[28:31], s3 offen offset:2048 lds
    buffer_store_dwordx4 v[160:163], v3, s[32:35], s49 offen offset:2048 sc1
    v_mul_f32 v171, v171, |v171|
    v_mul_f32 v172, v172, |v172|
    v_mul_f32 v173, v173, |v173|
    v_mul_f32 v174, v174, |v174|
    v_mul_f32 v175, v175, |v175|
    buffer_load_dwordx4 v55, s[28:31], s3 offen offset:3072 lds
    s_waitcnt lgkmcnt(6)
    s_add_u32 m0, s14, 12288
    s_cmp_ge_u32 s21, 7
    s_cselect_b32 s3, 42, 52
    s_lshl_b32 s3, s3, 15
    s_add_u32 s3, s3, s13
    v_cvt_pk_bf16_f32 v36, v168, v169
    v_cvt_pk_bf16_f32 v37, v170, v171
    v_cvt_pk_bf16_f32 v38, v172, v173
    v_cvt_pk_bf16_f32 v39, v174, v175
    v_pk_max_i16 v36, v36, 0
    v_pk_max_i16 v37, v37, 0
    v_pk_max_i16 v38, v38, 0
    v_pk_max_i16 v39, v39, 0
    v_or_b32 v168, v36, v61
    v_or_b32 v169, v37, v61
    v_or_b32 v170, v38, v61
    v_or_b32 v171, v39, v61
    v_mfma_f32_16x16x32_bf16 v[112:115], a[128:131], v[80:83], v[248:251]
    s_waitcnt vmcnt(11)
    ds_read_b128 v[104:107], v12 offset:2048
    buffer_store_dwordx4 v[168:171], v3, s[32:35], s49 offen offset:3072 sc1
    v_mfma_f32_16x16x32_bf16 v[116:119], a[128:131], v[84:87], v[248:251]
    s_lshr_b32 s5, s21, 2
    ds_read_b128 v[108:111], v13 offset:2048
    ds_read_b128 v[64:67], v10 offset:4096
    v_mfma_f32_16x16x32_bf16 v[120:123], a[132:135], v[80:83], v[252:255]
    s_mul_i32 s6, s5, 3
    s_mul_i32 s7, s5, 0x820
    s_xor_b32 s16, s21, s6
    v_mfma_f32_16x16x32_bf16 v[124:127], a[132:135], v[84:87], v[252:255]
    s_add_u32 s17, s16, 1
    ds_read_b128 v[68:71], v11 offset:4096
    s_and_b32 s17, s17, 7
    v_mfma_f32_16x16x32_bf16 v[128:131], a[128:131], v[88:91], v[248:251]
    s_or_b32 s17, s17, 4
    ds_read_b128 v[72:75], v12 offset:4096
    s_xor_b32 s17, s17, s74
    v_mfma_f32_16x16x32_bf16 v[132:135], a[128:131], v[92:95], v[248:251]
    s_xor_b32 s16, s16, s74
    ds_read_b128 v[76:79], v13 offset:4096
    s_sub_u32 s17, s17, s16
    v_mfma_f32_16x16x32_bf16 v[112:115], a[136:139], v[96:99], v[112:115]
    s_lshl_b32 s17, s17, 12
    ds_read_b128 v[80:83], v10 offset:6144
    s_sub_u32 s17, s17, 2048
    v_mfma_f32_16x16x32_bf16 v[116:119], a[136:139], v[100:103], v[116:119]
    s_lshl_b32 s16, s16, 12
    ds_read_b128 v[84:87], v11 offset:6144
    s_add_u32 s16, s16, s69
    v_mfma_f32_16x16x32_bf16 v[120:123], a[140:143], v[96:99], v[120:123]
    v_xor_b32 v2, s6, v14
    v_lshl_add_u32 v4, v15, 6, s16
    ds_read_b64_tr_b16 a[64:65], v56 offset:0
    ds_read_b64_tr_b16 a[68:69], v57 offset:0
    ds_read_b64_tr_b16 a[72:73], v58 offset:0
    v_mfma_f32_16x16x32_bf16 v[124:127], a[140:143], v[100:103], v[124:127]
    s_waitcnt lgkmcnt(9)
    ds_read_b128 v[88:91], v12 offset:6144
    v_add_u32 v5, s5, v2
    v_mfma_f32_16x16x32_bf16 v[128:131], a[136:139], v[104:107], v[128:131]
    ds_read_b128 v[92:95], v13 offset:6144
    v_ashrrev_i32 v62, 31, v61
    v_mfma_f32_16x16x32_bf16 v[132:135], a[136:139], v[108:111], v[132:135]
    s_waitcnt lgkmcnt(9)
    ds_read_b128 v[96:99], v10 offset:8192
    v_and_b32 v63, 0x7fff7fff, v62
    v_mfma_f32_16x16x32_bf16 v[112:115], a[144:147], v[64:67], v[112:115]
    ds_read_b128 v[100:103], v11 offset:8192
    v_and_b32 v62, 0x7fff8000, v62
    v_mfma_f32_16x16x32_bf16 v[116:119], a[144:147], v[68:71], v[116:119]
    v_lshrrev_b32 v8, 1, v2
    v_xor_b32 v8, v8, v60
    v_mfma_f32_16x16x32_bf16 v[120:123], a[148:151], v[64:67], v[120:123]
    ds_read_b128 v[104:107], v12 offset:8192
    v_lshl_add_u32 v40, v8, 4, v4
    v_mfma_f32_16x16x32_bf16 v[124:127], a[148:151], v[68:71], v[124:127]
    s_waitcnt lgkmcnt(10)
    ds_read_b128 v[108:111], v13 offset:8192
    v_and_b32 v8, 1, v2
    v_mfma_f32_16x16x32_bf16 v[128:131], a[144:147], v[72:75], v[128:131]
    ds_read_b128 v[64:67], v10 offset:10240
    v_lshl_add_u32 v40, v8, 3, v40
    v_mfma_f32_16x16x32_bf16 v[132:135], a[144:147], v[76:79], v[132:135]
    s_waitcnt lgkmcnt(10)
    ds_read_b128 v[68:71], v11 offset:10240
    v_xor_b32 v40, s7, v40
    v_mfma_f32_16x16x32_bf16 v[112:115], a[152:155], v[80:83], v[112:115]
    ds_read_b128 v[72:75], v12 offset:10240
    v_lshrrev_b32 v8, 1, v5
    ds_read_b64_tr_b16 a[76:77], v59 offset:0
    v_mfma_f32_16x16x32_bf16 v[116:119], a[152:155], v[84:87], v[116:119]
    ds_read_b128 v[76:79], v13 offset:10240
    v_xor_b32 v8, v8, v60
    v_mfma_f32_16x16x32_bf16 v[120:123], a[156:159], v[80:83], v[120:123]
    ds_read_b64_tr_b16 a[66:67], v56 offset:2048
    v_lshl_add_u32 v48, v8, 4, v4
    v_mfma_f32_16x16x32_bf16 v[124:127], a[156:159], v[84:87], v[124:127]
    s_waitcnt lgkmcnt(10)
    ds_read_b128 v[80:83], v10 offset:12288
    v_and_b32 v8, 1, v5
    v_mfma_f32_16x16x32_bf16 v[128:131], a[152:155], v[88:91], v[128:131]
    ds_read_b128 v[84:87], v11 offset:12288
    v_lshl_add_u32 v48, v8, 3, v48
    v_mfma_f32_16x16x32_bf16 v[132:135], a[152:155], v[92:95], v[132:135]
    s_waitcnt lgkmcnt(10)
    ds_read_b128 v[88:91], v12 offset:12288
    v_xor_b32 v48, s7, v48
    v_mfma_f32_16x16x32_bf16 v[112:115], a[160:163], v[96:99], v[112:115]
    ds_read_b128 v[92:95], v13 offset:12288
    v_mfma_f32_16x16x32_bf16 v[116:119], a[160:163], v[100:103], v[116:119]
    ds_read_b64_tr_b16 a[70:71], v57 offset:2048
    v_mfma_f32_16x16x32_bf16 v[120:123], a[164:167], v[96:99], v[120:123]
    ds_read_b64_tr_b16 a[74:75], v58 offset:2048
    buffer_load_dwordx4 v52, s[28:31], s3 offen offset:0 lds
    v_mfma_f32_16x16x32_bf16 v[124:127], a[164:167], v[100:103], v[124:127]
    s_waitcnt lgkmcnt(11)
    ds_read_b128 v[96:99], v10 offset:14336
    v_xor_b32 v42, 32, v40
    v_mfma_f32_16x16x32_bf16 v[128:131], a[160:163], v[104:107], v[128:131]
    ds_read_b128 v[100:103], v11 offset:14336
    buffer_load_dwordx4 v53, s[28:31], s3 offen offset:1024 lds
    v_mfma_f32_16x16x32_bf16 v[132:135], a[160:163], v[108:111], v[132:135]
    s_waitcnt lgkmcnt(11)
    ds_read_b128 v[104:107], v12 offset:14336
    v_xor_b32 v44, 2048, v40
    v_mfma_f32_16x16x32_bf16 v[112:115], a[168:171], v[64:67], v[112:115]
    ds_read_b128 v[108:111], v13 offset:14336
    buffer_load_dwordx4 v54, s[28:31], s3 offen offset:2048 lds
    v_mfma_f32_16x16x32_bf16 v[116:119], a[168:171], v[68:71], v[116:119]
    ds_read_b64_tr_b16 a[78:79], v59 offset:2048
    v_xor_b32 v46, 2080, v40
    v_mfma_f32_16x16x32_bf16 v[120:123], a[172:175], v[64:67], v[120:123]
    buffer_load_dwordx4 v55, s[28:31], s3 offen offset:3072 lds
    v_mfma_f32_16x16x32_bf16 v[124:127], a[172:175], v[68:71], v[124:127]
    s_waitcnt lgkmcnt(10)
    ds_read_b128 v[64:67], v10 offset:16384
    ds_read_b128 v[68:71], v11 offset:16384
    v_mfma_f32_16x16x32_bf16 v[128:131], a[168:171], v[72:75], v[128:131]
    s_add_u32 m0, s14, 16384
    v_xor_b32 v49, 32, v48
    v_xor_b32 v50, 2048, v48
    v_mfma_f32_16x16x32_bf16 v[132:135], a[168:171], v[76:79], v[132:135]
    s_waitcnt lgkmcnt(10)
    ds_read_b128 v[72:75], v12 offset:16384
    v_xor_b32 v51, 2080, v48
    s_add_u32 s3, s15, 131072
    v_mfma_f32_16x16x32_bf16 v[112:115], a[176:179], v[80:83], v[112:115]
    s_waitcnt vmcnt(11)
    ds_read_b128 v[76:79], v13 offset:16384
    v_lshrrev_b32 v5, 2, v5
    v_mfma_f32_16x16x32_bf16 v[116:119], a[176:179], v[84:87], v[116:119]
    s_lshl_b32 s16, s22, 7
    ds_read_b64_tr_b16 a[80:81], v56 offset:4096
    ds_read_b64_tr_b16 a[84:85], v57 offset:4096
    v_mfma_f32_16x16x32_bf16 v[120:123], a[180:183], v[80:83], v[120:123]
    s_add_u32 s16, s16, 156160
    ds_read_b64_tr_b16 a[88:89], v58 offset:4096
    ds_read_b64_tr_b16 a[92:93], v59 offset:4096
    v_mfma_f32_16x16x32_bf16 v[124:127], a[180:183], v[84:87], v[124:127]
    s_waitcnt lgkmcnt(11)
    ds_read_b128 v[80:83], v10 offset:18432
    buffer_load_dwordx4 v52, s[28:31], s3 offen offset:0 lds
    v_mfma_f32_16x16x32_bf16 v[128:131], a[176:179], v[88:91], v[128:131]
    ds_read_b128 v[84:87], v11 offset:18432
    v_lshl_add_u32 v50, v5, 11, v50
    v_mfma_f32_16x16x32_bf16 v[132:135], a[176:179], v[92:95], v[132:135]
    ds_read_b128 v[88:91], v12 offset:18432
    buffer_load_dwordx4 v53, s[28:31], s3 offen offset:1024 lds
    v_mfma_f32_16x16x32_bf16 v[112:115], a[184:187], v[96:99], v[112:115]
    v_mad_i32_i24 v48, v5, s17, v48
    v_lshl_add_u32 v6, v15, 3, s16
    v_mfma_f32_16x16x32_bf16 v[116:119], a[184:187], v[100:103], v[116:119]
    ds_read_b128 v[92:95], v13 offset:18432
    buffer_load_dwordx4 v54, s[28:31], s3 offen offset:2048 lds
    v_mfma_f32_16x16x32_bf16 v[120:123], a[188:191], v[96:99], v[120:123]
    ds_read_b64_tr_b16 a[82:83], v56 offset:6144
    ds_read_b64_tr_b16 a[86:87], v57 offset:6144
    v_mfma_f32_16x16x32_bf16 v[124:127], a[188:191], v[100:103], v[124:127]
    s_waitcnt lgkmcnt(12)
    ds_read_b128 v[96:99], v10 offset:20480
    v_mfma_f32_16x16x32_bf16 v[128:131], a[184:187], v[104:107], v[128:131]
    ds_read_b128 v[100:103], v11 offset:20480
    v_mfma_f32_16x16x32_bf16 v[132:135], a[184:187], v[108:111], v[132:135]
    ds_read_b128 v[104:107], v12 offset:20480
    v_mfma_f32_16x16x32_bf16 v[112:115], a[192:195], v[64:67], v[112:115]
    ds_read_b128 v[108:111], v13 offset:20480
    v_mfma_f32_16x16x32_bf16 v[116:119], a[192:195], v[68:71], v[116:119]
    ds_read_b64_tr_b16 a[90:91], v58 offset:6144
    buffer_load_dwordx4 v55, s[28:31], s3 offen offset:3072 lds
    v_mfma_f32_16x16x32_bf16 v[120:123], a[196:199], v[64:67], v[120:123]
    s_add_u32 m0, s14, 0
    ds_read_b64_tr_b16 a[94:95], v59 offset:6144
    ds_read_b64 v[40:41], v40
    v_mfma_f32_16x16x32_bf16 v[124:127], a[196:199], v[68:71], v[124:127]
    s_waitcnt lgkmcnt(12)
    ds_read_b128 v[64:67], v10 offset:22528
    s_add_u32 s3, s15, 163840
    v_mfma_f32_16x16x32_bf16 v[128:131], a[192:195], v[72:75], v[128:131]
    ds_read_b128 v[68:71], v11 offset:22528
    s_waitcnt vmcnt(9)
    v_mfma_f32_16x16x32_bf16 v[132:135], a[192:195], v[76:79], v[132:135]
    s_waitcnt lgkmcnt(12)
    ds_read_b128 v[72:75], v12 offset:22528
    v_mfma_f32_16x16x32_bf16 v[112:115], a[200:203], v[80:83], v[112:115]
    ds_read_b128 v[76:79], v13 offset:22528
    v_mfma_f32_16x16x32_bf16 v[116:119], a[200:203], v[84:87], v[116:119]
    v_mfma_f32_16x16x32_bf16 v[120:123], a[204:207], v[80:83], v[120:123]
    ds_read_b64_tr_b16 a[96:97], v56 offset:8192
    ds_read_b64_tr_b16 a[100:101], v57 offset:8192
    v_mfma_f32_16x16x32_bf16 v[124:127], a[204:207], v[84:87], v[124:127]
    s_waitcnt lgkmcnt(12)
    ds_read_b128 v[80:83], v10 offset:24576
    v_mfma_f32_16x16x32_bf16 v[128:131], a[200:203], v[88:91], v[128:131]
    ds_read_b128 v[84:87], v11 offset:24576
    buffer_load_dwordx4 v52, s[28:31], s3 offen offset:0 lds
    v_mfma_f32_16x16x32_bf16 v[132:135], a[200:203], v[92:95], v[132:135]
    s_waitcnt lgkmcnt(12)
    ds_read_b128 v[88:91], v12 offset:24576
    v_mfma_f32_16x16x32_bf16 v[112:115], a[208:211], v[96:99], v[112:115]
    s_waitcnt vmcnt(9)
    ds_read_b128 v[92:95], v13 offset:24576
    buffer_load_dwordx4 v53, s[28:31], s3 offen offset:1024 lds
    v_mfma_f32_16x16x32_bf16 v[116:119], a[208:211], v[100:103], v[116:119]
    ds_read_b64_tr_b16 a[104:105], v58 offset:8192
    v_mfma_f32_16x16x32_bf16 v[120:123], a[212:215], v[96:99], v[120:123]
    ds_read_b64_tr_b16 a[108:109], v59 offset:8192
    buffer_load_dwordx4 v54, s[28:31], s3 offen offset:2048 lds
    v_mfma_f32_16x16x32_bf16 v[124:127], a[212:215], v[100:103], v[124:127]
    s_waitcnt lgkmcnt(11)
    ds_read_b128 v[96:99], v10 offset:26624
    v_mfma_f32_16x16x32_bf16 v[128:131], a[208:211], v[104:107], v[128:131]
    ds_read_b128 v[100:103], v11 offset:26624
    buffer_load_dwordx4 v55, s[28:31], s3 offen offset:3072 lds
    v_mfma_f32_16x16x32_bf16 v[132:135], a[208:211], v[108:111], v[132:135]
    s_waitcnt lgkmcnt(11)
    ds_read_b128 v[104:107], v12 offset:26624
    s_add_u32 m0, s14, 4096
    v_mfma_f32_16x16x32_bf16 v[112:115], a[216:219], v[64:67], v[112:115]
    s_add_u32 s3, s15, 196608
    ds_read_b128 v[108:111], v13 offset:26624
    buffer_load_dwordx4 v52, s[28:31], s3 offen offset:0 lds
    v_mfma_f32_16x16x32_bf16 v[116:119], a[216:219], v[68:71], v[116:119]
    ds_read_b64_tr_b16 a[98:99], v56 offset:10240
    v_mfma_f32_16x16x32_bf16 v[120:123], a[220:223], v[64:67], v[120:123]
    ds_read_b64_tr_b16 a[102:103], v57 offset:10240
    ds_read_b64_tr_b16 a[106:107], v58 offset:10240
    v_mfma_f32_16x16x32_bf16 v[124:127], a[220:223], v[68:71], v[124:127]
    s_waitcnt lgkmcnt(12)
    ds_read_b128 v[64:67], v10 offset:28672
    buffer_load_dwordx4 v53, s[28:31], s3 offen offset:1024 lds
    v_mfma_f32_16x16x32_bf16 v[128:131], a[216:219], v[72:75], v[128:131]
    ds_read_b128 v[68:71], v11 offset:28672
    v_mfma_f32_16x16x32_bf16 v[132:135], a[216:219], v[76:79], v[132:135]
    s_waitcnt lgkmcnt(12)
    ds_read_b128 v[72:75], v12 offset:28672
    v_mfma_f32_16x16x32_bf16 v[112:115], a[224:227], v[80:83], v[112:115]
    ds_read_b128 v[76:79], v13 offset:28672
    v_mfma_f32_16x16x32_bf16 v[116:119], a[224:227], v[84:87], v[116:119]
    ds_read_b64_tr_b16 a[110:111], v59 offset:10240
    v_mfma_f32_16x16x32_bf16 v[120:123], a[228:231], v[80:83], v[120:123]
    s_waitcnt vmcnt(10)
    ds_read_b64_tr_b16 a[112:113], v56 offset:12288
    buffer_load_dwordx4 v54, s[28:31], s3 offen offset:2048 lds
    v_mfma_f32_16x16x32_bf16 v[124:127], a[228:231], v[84:87], v[124:127]
    s_waitcnt lgkmcnt(12)
    ds_read_b128 v[80:83], v10 offset:30720
    v_mfma_f32_16x16x32_bf16 v[128:131], a[224:227], v[88:91], v[128:131]
    s_mov_b32 s4, 28672
    s_cmp_ge_u32 s21, 1
    s_cselect_b32 s4, 0, s4
    v_mfma_f32_16x16x32_bf16 v[132:135], a[224:227], v[92:95], v[132:135]
    s_waitcnt lgkmcnt(11)
    ds_read_b128 v[84:87], v11 offset:30720
    buffer_load_dwordx4 v55, s[28:31], s3 offen offset:3072 lds
    v_mfma_f32_16x16x32_bf16 v[112:115], a[232:235], v[96:99], v[112:115]
    s_add_u32 s4, s4, s10
    ds_read_b128 v[88:91], v12 offset:30720
    v_mfma_f32_16x16x32_bf16 v[116:119], a[232:235], v[100:103], v[116:119]
    s_waitcnt lgkmcnt(7)
    ds_read_b128 v[92:95], v13 offset:30720
    buffer_load_dwordx4 v[144:147], v3, s[32:35], s4 offen offset:0 sc1
    v_mfma_f32_16x16x32_bf16 v[112:115], a[240:243], v[64:67], v[112:115]
    ds_read_b64_tr_b16 a[116:117], v57 offset:12288
    ds_read_b64_tr_b16 a[120:121], v58 offset:12288
    v_mfma_f32_16x16x32_bf16 v[116:119], a[240:243], v[68:71], v[116:119]
    s_waitcnt lgkmcnt(7)
    ds_read_b64_tr_b16 a[124:125], v59 offset:12288
    buffer_load_dwordx4 v[148:151], v3, s[32:35], s4 offen offset:1024 sc1
    ds_read_b64_tr_b16 a[114:115], v56 offset:14336
    s_add_u32 m0, s14, 8192
    ds_read_b64_tr_b16 a[118:119], v57 offset:14336
    s_add_u32 s3, s15, 229376
    ds_read_b64_tr_b16 a[122:123], v58 offset:14336
    ds_read_b64_tr_b16 a[126:127], v59 offset:14336
    s_waitcnt vmcnt(10)
    buffer_load_dwordx4 v[152:155], v3, s[32:35], s4 offen offset:2048 sc1
    ds_read_b64_tr_b16 a[128:129], v56 offset:16384
    s_waitcnt lgkmcnt(10)
    v_mfma_f32_16x16x32_bf16 v[112:115], a[248:251], v[80:83], v[112:115]
    ds_read_b64_tr_b16 a[132:133], v57 offset:16384
    ds_read_b64_tr_b16 a[136:137], v58 offset:16384
    v_mfma_f32_16x16x32_bf16 v[116:119], a[248:251], v[84:87], v[116:119]
    ds_read_b64_tr_b16 a[140:141], v59 offset:16384
    buffer_load_dwordx4 v[156:159], v3, s[32:35], s4 offen offset:3072 sc1
    v_mfma_f32_16x16x32_bf16 v[120:123], a[236:239], v[96:99], v[120:123]
    s_mov_b32 s4, 57344
    s_cmp_ge_u32 s21, 2
    s_cselect_b32 s4, 28672, s4
    v_mfma_f32_16x16x32_bf16 v[124:127], a[236:239], v[100:103], v[124:127]
    s_add_u32 s4, s4, s10
    ds_read_b64_tr_b16 a[130:131], v56 offset:18432
    buffer_load_dwordx4 v[160:163], v3, s[32:35], s4 offen offset:0 sc1
    v_mfma_f32_16x16x32_bf16 v[120:123], a[244:247], v[64:67], v[120:123]
    ds_read_b64 v[42:43], v42
    ds_read_b64 v[44:45], v44
    v_mfma_f32_16x16x32_bf16 v[124:127], a[244:247], v[68:71], v[124:127]
    ds_read_b64_tr_b16 a[134:135], v57 offset:18432
    buffer_load_dwordx4 v[164:167], v3, s[32:35], s4 offen offset:1024 sc1
    v_mfma_f32_16x16x32_bf16 v[120:123], a[252:255], v[80:83], v[120:123]
    ds_read_b64 v[46:47], v46
    ds_read_u16 v49, v49
    v_mfma_f32_16x16x32_bf16 v[124:127], a[252:255], v[84:87], v[124:127]
    ds_read_b64_tr_b16 a[138:139], v58 offset:18432
    buffer_load_dwordx4 v[168:171], v3, s[32:35], s4 offen offset:2048 sc1
    v_mfma_f32_16x16x32_bf16 v[128:131], a[232:235], v[104:107], v[128:131]
    ds_read_u16 v51, v51
    ds_read_u16 v50, v50
    v_mfma_f32_16x16x32_bf16 v[132:135], a[232:235], v[108:111], v[132:135]
    ds_read_b64_tr_b16 a[142:143], v59 offset:18432
    buffer_load_dwordx4 v[172:175], v3, s[32:35], s4 offen offset:3072 sc1
    v_mfma_f32_16x16x32_bf16 v[128:131], a[240:243], v[72:75], v[128:131]
    s_mov_b32 s4, 86016
    s_cmp_ge_u32 s21, 3
    s_cselect_b32 s4, 57344, s4
    v_mfma_f32_16x16x32_bf16 v[132:135], a[240:243], v[76:79], v[132:135]
    s_waitcnt lgkmcnt(12)
    ds_read_u16 v48, v48
    ds_read_b64 v[6:7], v6
    v_mfma_f32_16x16x32_bf16 v[128:131], a[248:251], v[88:91], v[128:131]
    s_add_u32 s4, s4, s10
    s_waitcnt vmcnt(12)
    buffer_load_dwordx4 v[176:179], v3, s[32:35], s4 offen offset:0 sc1
    v_mfma_f32_16x16x32_bf16 v[132:135], a[248:251], v[92:95], v[132:135]
    v_mul_f32 v112, v112, |v112|
    v_mul_f32 v113, v113, |v113|
    v_mul_f32 v114, v114, |v114|
    v_mul_f32 v115, v115, |v115|
    v_mul_f32 v116, v116, |v116|
    v_mul_f32 v117, v117, |v117|
    v_mul_f32 v118, v118, |v118|
    v_mul_f32 v119, v119, |v119|
    v_cvt_pk_bf16_f32 v112, v112, v113
    v_cvt_pk_bf16_f32 v113, v114, v115
    v_cvt_pk_bf16_f32 v114, v116, v117
    v_cvt_pk_bf16_f32 v115, v118, v119
    ds_read_b64_tr_b16 a[144:145], v56 offset:0
    ds_read_b64_tr_b16 a[148:149], v57 offset:0
    ds_read_b64_tr_b16 a[152:153], v58 offset:0
    buffer_load_dwordx4 v52, s[28:31], s3 offen offset:0 lds
    v_pk_max_i16 v112, v112, 0
    v_pk_max_i16 v113, v113, 0
    v_pk_max_i16 v114, v114, 0
    v_pk_max_i16 v115, v115, 0
    v_or_b32 v112, v112, v61
    v_or_b32 v113, v113, v61
    v_or_b32 v114, v114, v61
    v_or_b32 v115, v115, v61
    v_mul_f32 v120, v120, |v120|
    ds_read_b64_tr_b16 a[156:157], v59 offset:0
    ds_read_b64_tr_b16 a[146:147], v56 offset:2048
    ds_read_b64_tr_b16 a[150:151], v57 offset:2048
    buffer_load_dwordx4 v[180:183], v3, s[32:35], s4 offen offset:1024 sc1
    ds_read_b64_tr_b16 a[154:155], v58 offset:2048
    ds_read_b64_tr_b16 a[158:159], v59 offset:2048
    buffer_store_dwordx4 v[112:115], v3, s[32:35], s50 offen sc1
    v_mul_f32 v121, v121, |v121|
    v_mul_f32 v122, v122, |v122|
    v_mul_f32 v123, v123, |v123|
    buffer_load_dwordx4 v53, s[28:31], s3 offen offset:1024 lds
    v_mul_f32 v124, v124, |v124|
    v_mul_f32 v125, v125, |v125|
    v_mul_f32 v126, v126, |v126|
    v_mul_f32 v127, v127, |v127|
    v_cvt_pk_bf16_f32 v116, v120, v121
    v_cvt_pk_bf16_f32 v117, v122, v123
    v_cvt_pk_bf16_f32 v118, v124, v125
    v_cvt_pk_bf16_f32 v119, v126, v127
    v_pk_max_i16 v116, v116, 0
    v_pk_max_i16 v117, v117, 0
    v_pk_max_i16 v118, v118, 0
    v_pk_max_i16 v119, v119, 0
    v_or_b32 v116, v116, v61
    v_or_b32 v117, v117, v61
    v_or_b32 v118, v118, v61
    v_or_b32 v119, v119, v61
    v_mul_f32 v128, v128, |v128|
    v_mul_f32 v129, v129, |v129|
    v_mul_f32 v130, v130, |v130|
    v_mul_f32 v131, v131, |v131|
    v_mul_f32 v132, v132, |v132|
    v_mul_f32 v133, v133, |v133|
    s_waitcnt vmcnt(13)
    ds_read_b64_tr_b16 a[160:161], v56 offset:4096
    ds_read_b64_tr_b16 a[164:165], v57 offset:4096
    ds_read_b64_tr_b16 a[168:169], v58 offset:4096
    buffer_store_dwordx4 v[116:119], v3, s[32:35], s54 offen sc1
    v_mul_f32 v134, v134, |v134|
    v_mul_f32 v135, v135, |v135|
    v_cvt_pk_bf16_f32 v120, v128, v129
    v_cvt_pk_bf16_f32 v121, v130, v131
    v_cvt_pk_bf16_f32 v122, v132, v133
    v_cvt_pk_bf16_f32 v123, v134, v135
    v_pk_max_i16 v120, v120, 0
    v_pk_max_i16 v121, v121, 0
    v_pk_max_i16 v122, v122, 0
    v_pk_max_i16 v123, v123, 0
    v_or_b32 v120, v120, v61
    v_or_b32 v121, v121, v61
    v_or_b32 v122, v122, v61
    v_or_b32 v123, v123, v61
    v_mfma_f32_16x16x32_bf16 v[64:67], a[0:3], v[24:27], 0
    s_lshl_b32 s5, s5, 2
    ds_read_b64_tr_b16 a[172:173], v59 offset:4096
    buffer_store_dwordx4 v[120:123], v3, s[32:35], s51 offen sc1
    v_mfma_f32_16x16x32_bf16 v[68:71], a[4:7], v[24:27], 0
    s_mul_i32 s5, s5, 0x01010000
    ds_read_b64_tr_b16 a[162:163], v56 offset:6144
    ds_read_b64_tr_b16 a[166:167], v57 offset:6144
    v_mfma_f32_16x16x32_bf16 v[72:75], a[8:11], v[24:27], 0
    s_or_b32 s6, s5, 0x03020c0c
    ds_read_b64_tr_b16 a[170:171], v58 offset:6144
    ds_read_b64_tr_b16 a[174:175], v59 offset:6144
    v_mfma_f32_16x16x32_bf16 v[76:79], a[12:15], v[24:27], 0
    s_xor_b32 s7, s6, 0x04040000
    s_movk_i32 s16, 0x3f80
    s_mov_b32 s17, 0x3f800000
    v_mfma_f32_16x16x32_bf16 v[80:83], a[0:3], v[28:31], 0
    s_waitcnt lgkmcnt(6)
    buffer_load_dwordx4 v[184:187], v3, s[32:35], s4 offen offset:2048 sc1
    v_mfma_f32_16x16x32_bf16 v[84:87], a[4:7], v[28:31], 0
    v_lshlrev_b32 v128, 16, v48
    v_perm_b32 v129, v41, v40, s6
    v_mfma_f32_16x16x32_bf16 v[88:91], a[8:11], v[28:31], 0
    v_lshlrev_b32 v130, 16, v41
    v_perm_b32 v131, v41, v40, s7
    v_mfma_f32_16x16x32_bf16 v[92:95], a[12:15], v[28:31], 0
    v_lshlrev_b32 v132, 16, v49
    v_perm_b32 v133, v43, v42, s6
    v_mfma_f32_16x16x32_bf16 v[96:99], a[0:3], v[32:35], 0
    s_waitcnt vmcnt(14)
    buffer_load_dwordx4 v[188:191], v3, s[32:35], s4 offen offset:3072 sc1
    v_mfma_f32_16x16x32_bf16 v[100:103], a[4:7], v[32:35], 0
    s_mov_b32 s4, 114688
    s_cmp_ge_u32 s21, 4
    s_cselect_b32 s4, 86016, s4
    v_mfma_f32_16x16x32_bf16 v[104:107], a[8:11], v[32:35], 0
    s_add_u32 s4, s4, s10
    v_lshl_add_u64 v[144:145], v[144:145], 0, v[62:63]
    v_lshl_add_u64 v[146:147], v[146:147], 0, v[62:63]
    v_mfma_f32_16x16x32_bf16 v[108:111], a[12:15], v[32:35], 0
    v_lshlrev_b32 v134, 16, v43
    v_perm_b32 v135, v43, v42, s7
    buffer_load_dwordx4 v54, s[28:31], s3 offen offset:2048 lds
    v_lshlrev_b32 v136, 16, v50
    v_perm_b32 v137, v45, v44, s6
    v_lshlrev_b32 v138, 16, v45
    v_perm_b32 v139, v45, v44, s7
    v_lshlrev_b32 v140, 16, v51
    v_perm_b32 v141, v47, v46, s6
    v_lshlrev_b32 v142, 16, v47
    v_perm_b32 v143, v47, v46, s7
    v_pk_fma_f32 v[128:129], v[128:129], v[6:7], v[6:7] op_sel:[0,0,1] op_sel_hi:[1,0,1]
    v_pk_fma_f32 v[130:131], v[130:131], v[6:7], v[6:7] op_sel:[0,0,1] op_sel_hi:[1,0,1]
    v_pk_fma_f32 v[132:133], v[132:133], v[6:7], v[6:7] op_sel:[0,0,1] op_sel_hi:[1,0,1]
    buffer_load_dwordx4 v[192:195], v3, s[32:35], s4 offen offset:0 sc1
    v_pk_fma_f32 v[134:135], v[134:135], v[6:7], v[6:7] op_sel:[0,0,1] op_sel_hi:[1,0,1]
    v_pk_fma_f32 v[136:137], v[136:137], v[6:7], v[6:7] op_sel:[0,0,1] op_sel_hi:[1,0,1]
    v_pk_fma_f32 v[138:139], v[138:139], v[6:7], v[6:7] op_sel:[0,0,1] op_sel_hi:[1,0,1]
    v_pk_fma_f32 v[140:141], v[140:141], v[6:7], v[6:7] op_sel:[0,0,1] op_sel_hi:[1,0,1]
    v_pk_fma_f32 v[142:143], v[142:143], v[6:7], v[6:7] op_sel:[0,0,1] op_sel_hi:[1,0,1]
    v_dot2_f32_bf16 v128, v16, s16, v128
    v_dot2_f32_bf16 v129, v16, s17, v129
    v_dot2_f32_bf16 v130, v17, s16, v130
    v_dot2_f32_bf16 v131, v17, s17, v131
    v_dot2_f32_bf16 v132, v18, s16, v132
    v_dot2_f32_bf16 v133, v18, s17, v133
    buffer_load_dwordx4 v55, s[28:31], s3 offen offset:3072 lds
    v_dot2_f32_bf16 v134, v19, s16, v134
    v_dot2_f32_bf16 v135, v19, s17, v135
    v_dot2_f32_bf16 v136, v20, s16, v136
    v_dot2_f32_bf16 v137, v20, s17, v137
    v_dot2_f32_bf16 v138, v21, s16, v138
    v_dot2_f32_bf16 v139, v21, s17, v139
    s_add_u32 m0, s14, 12288
    v_dot2_f32_bf16 v140, v22, s16, v140
    v_dot2_f32_bf16 v141, v22, s17, v141
    v_dot2_f32_bf16 v142, v23, s16, v142
    v_dot2_f32_bf16 v143, v23, s17, v143
    buffer_load_dwordx4 v[196:199], v3, s[32:35], s4 offen offset:1024 sc1
    s_add_u32 s3, s15, 262144
    s_lshl_b32 s16, s22, 12
    v_add_u32 v7, s16, v3
    v_xor_b32 v4, 0x3000, v7
    v_xor_b32 v5, 0x2000, v7
    v_xor_b32 v6, 0x1000, v7
    s_lshl_b32 s16, s67, 4
    v_add_u32 v2, s16, v15
    s_cmp_ge_u32 s22, 2
    s_cselect_b32 s16, s23, s20
    s_lshl_b32 s16, s16, 10
    s_add_u32 s16, s16, s18
    v_lshl_add_u32 v2, v2, 16, s16
    v_and_b32 v8, 1, v14
    v_lshl_add_u32 v2, v8, 5, v2
    v_lshrrev_b32 v8, 1, v14
    v_lshl_add_u32 v2, v8, 4, v2
    buffer_load_dwordx4 v[200:203], v3, s[32:35], s4 offen offset:2048 sc1
    v_mfma_f32_16x16x32_bf16 v[128:131], a[0:3], v[36:39], v[128:131]
    v_lshl_add_u64 v[148:149], v[148:149], 0, v[62:63]
    v_or3_b32 v10, v144, v145, v146
    v_mfma_f32_16x16x32_bf16 v[132:135], a[4:7], v[36:39], v[132:135]
    buffer_load_dwordx4 v[204:207], v3, s[32:35], s4 offen offset:3072 sc1
    v_mfma_f32_16x16x32_bf16 v[136:139], a[8:11], v[36:39], v[136:139]
    s_mov_b32 s4, 143360
    s_cmp_ge_u32 s21, 5
    s_cselect_b32 s4, 114688, s4
    v_mfma_f32_16x16x32_bf16 v[140:143], a[12:15], v[36:39], v[140:143]
    s_barrier
    s_add_u32 s4, s4, s10
    buffer_load_dwordx4 v52, s[28:31], s3 offen offset:0 lds
    v_lshl_add_u64 v[150:151], v[150:151], 0, v[62:63]
    v_or3_b32 v10, v10, v147, v148
    v_or3_b32 v10, v10, v149, v150
    v_bitop3_b32 v10, v10, v151, s44 bitop3:0xa8
    v_cmp_ne_u32 vcc, 0, v10
    s_cbranch_vccnz fnet_kernel_nx1
fnet_kernel_go2:
    v_mfma_f32_16x16x32_bf16 v[64:67], a[16:19], v[144:147], v[64:67]
    s_waitcnt vmcnt(20)
    v_mfma_f32_16x16x32_bf16 v[68:71], a[20:23], v[144:147], v[68:71]
    buffer_load_dwordx4 v[208:211], v3, s[32:35], s4 offen offset:0 sc1
    v_mfma_f32_16x16x32_bf16 v[72:75], a[24:27], v[144:147], v[72:75]
    v_lshl_add_u64 v[152:153], v[152:153], 0, v[62:63]
    v_lshl_add_u64 v[154:155], v[154:155], 0, v[62:63]
    v_mfma_f32_16x16x32_bf16 v[76:79], a[28:31], v[144:147], v[76:79]
    v_lshl_add_u64 v[156:157], v[156:157], 0, v[62:63]
    v_or3_b32 v10, v152, v153, v154
    v_mfma_f32_16x16x32_bf16 v[80:83], a[16:19], v[148:151], v[80:83]
    v_mfma_f32_16x16x32_bf16 v[84:87], a[20:23], v[148:151], v[84:87]
    buffer_load_dwordx4 v[212:215], v3, s[32:35], s4 offen offset:1024 sc1
    v_mfma_f32_16x16x32_bf16 v[88:91], a[24:27], v[148:151], v[88:91]
    v_lshl_add_u64 v[158:159], v[158:159], 0, v[62:63]
    v_or3_b32 v10, v10, v155, v156
    v_mfma_f32_16x16x32_bf16 v[92:95], a[28:31], v[148:151], v[92:95]
    v_or3_b32 v10, v10, v157, v158
    v_bitop3_b32 v10, v10, v159, s44 bitop3:0xa8
    v_cmp_ne_u32 vcc, 0, v10
    s_cbranch_vccnz fnet_kernel_nx3
fnet_kernel_go4:
    v_mfma_f32_16x16x32_bf16 v[96:99], a[16:19], v[152:155], v[96:99]
    s_waitcnt vmcnt(20)
    v_lshl_add_u64 v[160:161], v[160:161], 0, v[62:63]
    v_lshl_add_u64 v[162:163], v[162:163], 0, v[62:63]
    v_mfma_f32_16x16x32_bf16 v[100:103], a[20:23], v[152:155], v[100:103]
    v_lshl_add_u64 v[164:165], v[164:165], 0, v[62:63]
    v_or3_b32 v10, v160, v161, v162
    v_mfma_f32_16x16x32_bf16 v[104:107], a[24:27], v[152:155], v[104:107]
    buffer_load_dwordx4 v[216:219], v3, s[32:35], s4 offen offset:2048 sc1
    v_mfma_f32_16x16x32_bf16 v[108:111], a[28:31], v[152:155], v[108:111]
    v_lshl_add_u64 v[166:167], v[166:167], 0, v[62:63]
    v_or3_b32 v10, v10, v163, v164
    v_mfma_f32_16x16x32_bf16 v[128:131], a[16:19], v[156:159], v[128:131]
    v_or3_b32 v10, v10, v165, v166
    v_bitop3_b32 v10, v10, v167, s44 bitop3:0xa8
    v_mfma_f32_16x16x32_bf16 v[132:135], a[20:23], v[156:159], v[132:135]
    v_cmp_ne_u32 vcc, 0, v10
    v_mfma_f32_16x16x32_bf16 v[136:139], a[24:27], v[156:159], v[136:139]
    v_mfma_f32_16x16x32_bf16 v[140:143], a[28:31], v[156:159], v[140:143]
    s_cbranch_vccnz fnet_kernel_nx5
fnet_kernel_go6:
    v_mfma_f32_16x16x32_bf16 v[64:67], a[32:35], v[160:163], v[64:67]
    s_waitcnt vmcnt(19)
    v_lshl_add_u64 v[168:169], v[168:169], 0, v[62:63]
    v_lshl_add_u64 v[170:171], v[170:171], 0, v[62:63]
    v_mfma_f32_16x16x32_bf16 v[68:71], a[36:39], v[160:163], v[68:71]
    v_lshl_add_u64 v[172:173], v[172:173], 0, v[62:63]
    v_or3_b32 v10, v168, v169, v170
    v_mfma_f32_16x16x32_bf16 v[72:75], a[40:43], v[160:163], v[72:75]
    v_mfma_f32_16x16x32_bf16 v[76:79], a[44:47], v[160:163], v[76:79]
    buffer_load_dwordx4 v[220:223], v3, s[32:35], s4 offen offset:3072 sc1
    v_mfma_f32_16x16x32_bf16 v[80:83], a[32:35], v[164:167], v[80:83]
    s_mov_b32 s4, 172032
    s_cmp_ge_u32 s21, 6
    s_cselect_b32 s4, 143360, s4
    v_mfma_f32_16x16x32_bf16 v[84:87], a[36:39], v[164:167], v[84:87]
    s_add_u32 s4, s4, s10
    v_lshl_add_u64 v[174:175], v[174:175], 0, v[62:63]
    v_or3_b32 v10, v10, v171, v172
    v_mfma_f32_16x16x32_bf16 v[88:91], a[40:43], v[164:167], v[88:91]
    buffer_load_dwordx4 v[224:227], v3, s[32:35], s4 offen offset:0 sc1
    v_mfma_f32_16x16x32_bf16 v[92:95], a[44:47], v[164:167], v[92:95]
    v_or3_b32 v10, v10, v173, v174
    v_bitop3_b32 v10, v10, v175, s44 bitop3:0xa8
    v_cmp_ne_u32 vcc, 0, v10
    s_cbranch_vccnz fnet_kernel_nx7
fnet_kernel_go8:
    v_mfma_f32_16x16x32_bf16 v[96:99], a[32:35], v[168:171], v[96:99]
    s_waitcnt vmcnt(18)
    v_lshl_add_u64 v[176:177], v[176:177], 0, v[62:63]
    v_lshl_add_u64 v[178:179], v[178:179], 0, v[62:63]
    v_mfma_f32_16x16x32_bf16 v[100:103], a[36:39], v[168:171], v[100:103]
    buffer_load_dwordx4 v[228:231], v3, s[32:35], s4 offen offset:1024 sc1
    v_mfma_f32_16x16x32_bf16 v[104:107], a[40:43], v[168:171], v[104:107]
    v_lshl_add_u64 v[180:181], v[180:181], 0, v[62:63]
    v_or3_b32 v10, v176, v177, v178
    v_mfma_f32_16x16x32_bf16 v[108:111], a[44:47], v[168:171], v[108:111]
    v_lshl_add_u64 v[182:183], v[182:183], 0, v[62:63]
    v_or3_b32 v10, v10, v179, v180
    v_mfma_f32_16x16x32_bf16 v[128:131], a[32:35], v[172:175], v[128:131]
    v_or3_b32 v10, v10, v181, v182
    v_bitop3_b32 v10, v10, v183, s44 bitop3:0xa8
    v_mfma_f32_16x16x32_bf16 v[132:135], a[36:39], v[172:175], v[132:135]
    buffer_load_dwordx4 v[232:235], v3, s[32:35], s4 offen offset:2048 sc1
    v_mfma_f32_16x16x32_bf16 v[136:139], a[40:43], v[172:175], v[136:139]
    v_cmp_ne_u32 vcc, 0, v10
    v_mfma_f32_16x16x32_bf16 v[140:143], a[44:47], v[172:175], v[140:143]
    s_cbranch_vccnz fnet_kernel_nx9
fnet_kernel_go10:
    v_mfma_f32_16x16x32_bf16 v[64:67], a[48:51], v[176:179], v[64:67]
    s_waitcnt vmcnt(14)
    v_lshl_add_u64 v[184:185], v[184:185], 0, v[62:63]
    v_lshl_add_u64 v[186:187], v[186:187], 0, v[62:63]
    v_mfma_f32_16x16x32_bf16 v[68:71], a[52:55], v[176:179], v[68:71]
    buffer_load_dwordx4 v[236:239], v3, s[32:35], s4 offen offset:3072 sc1
    v_mfma_f32_16x16x32_bf16 v[72:75], a[56:59], v[176:179], v[72:75]
    s_mov_b32 s4, 200704
    s_cmp_ge_u32 s21, 7
    s_cselect_b32 s4, 172032, s4
    v_mfma_f32_16x16x32_bf16 v[76:79], a[60:63], v[176:179], v[76:79]
    s_add_u32 s4, s4, s10
    v_lshl_add_u64 v[188:189], v[188:189], 0, v[62:63]
    v_or3_b32 v10, v184, v185, v186
    v_mfma_f32_16x16x32_bf16 v[80:83], a[48:51], v[180:183], v[80:83]
    v_lshl_add_u64 v[190:191], v[190:191], 0, v[62:63]
    v_or3_b32 v10, v10, v187, v188
    v_mfma_f32_16x16x32_bf16 v[84:87], a[52:55], v[180:183], v[84:87]
    s_waitcnt vmcnt(12)
    ds_read_b64_tr_b16 a[176:177], v56 offset:8192
    buffer_load_dwordx4 v[240:243], v3, s[32:35], s4 offen offset:0 sc1
    v_mfma_f32_16x16x32_bf16 v[88:91], a[56:59], v[180:183], v[88:91]
    ds_read_b64_tr_b16 a[180:181], v57 offset:8192
    ds_read_b64_tr_b16 a[184:185], v58 offset:8192
    v_mfma_f32_16x16x32_bf16 v[92:95], a[60:63], v[180:183], v[92:95]
    v_or3_b32 v10, v10, v189, v190
    v_bitop3_b32 v10, v10, v191, s44 bitop3:0xa8
    v_cmp_ne_u32 vcc, 0, v10
    ds_read_b64_tr_b16 a[188:189], v59 offset:8192
    buffer_load_dwordx4 v[244:247], v3, s[32:35], s4 offen offset:1024 sc1
    ds_read_b64_tr_b16 a[178:179], v56 offset:10240
    ds_read_b64_tr_b16 a[182:183], v57 offset:10240
    s_cbranch_vccnz fnet_kernel_nx11
fnet_kernel_go12:
    v_mfma_f32_16x16x32_bf16 v[96:99], a[48:51], v[184:187], v[96:99]
    s_waitcnt vmcnt(13)
    ds_read_b64_tr_b16 a[186:187], v58 offset:10240
    ds_read_b64_tr_b16 a[190:191], v59 offset:10240
    v_mfma_f32_16x16x32_bf16 v[100:103], a[52:55], v[184:187], v[100:103]
    v_lshl_add_u64 v[192:193], v[192:193], 0, v[62:63]
    v_lshl_add_u64 v[194:195], v[194:195], 0, v[62:63]
    v_mfma_f32_16x16x32_bf16 v[104:107], a[56:59], v[184:187], v[104:107]
    buffer_load_dwordx4 v[248:251], v3, s[32:35], s4 offen offset:2048 sc1
    v_mfma_f32_16x16x32_bf16 v[108:111], a[60:63], v[184:187], v[108:111]
    v_lshl_add_u64 v[196:197], v[196:197], 0, v[62:63]
    v_or3_b32 v10, v192, v193, v194
    v_mfma_f32_16x16x32_bf16 v[128:131], a[48:51], v[188:191], v[128:131]
    v_lshl_add_u64 v[198:199], v[198:199], 0, v[62:63]
    v_or3_b32 v10, v10, v195, v196
    v_mfma_f32_16x16x32_bf16 v[132:135], a[52:55], v[188:191], v[132:135]
    v_or3_b32 v10, v10, v197, v198
    v_bitop3_b32 v10, v10, v199, s44 bitop3:0xa8
    v_mfma_f32_16x16x32_bf16 v[136:139], a[56:59], v[188:191], v[136:139]
    buffer_load_dwordx4 v[252:255], v3, s[32:35], s4 offen offset:3072 sc1
    v_mfma_f32_16x16x32_bf16 v[140:143], a[60:63], v[188:191], v[140:143]
    s_add_u32 s4, s11, 16384
    v_cmp_ne_u32 vcc, 0, v10
    s_cbranch_vccnz fnet_kernel_nx13
fnet_kernel_go14:
    v_mfma_f32_16x16x32_bf16 v[64:67], a[64:67], v[192:195], v[64:67]
    s_waitcnt vmcnt(13)
    v_lshl_add_u64 v[200:201], v[200:201], 0, v[62:63]
    v_lshl_add_u64 v[202:203], v[202:203], 0, v[62:63]
    v_mfma_f32_16x16x32_bf16 v[68:71], a[68:71], v[192:195], v[68:71]
    buffer_load_dwordx4 v[144:147], v3, s[32:35], s4 offen offset:0 sc1
    v_mfma_f32_16x16x32_bf16 v[72:75], a[72:75], v[192:195], v[72:75]
    v_lshl_add_u64 v[204:205], v[204:205], 0, v[62:63]
    v_or3_b32 v10, v200, v201, v202
    v_mfma_f32_16x16x32_bf16 v[76:79], a[76:79], v[192:195], v[76:79]
    v_lshl_add_u64 v[206:207], v[206:207], 0, v[62:63]
    v_or3_b32 v10, v10, v203, v204
    v_mfma_f32_16x16x32_bf16 v[80:83], a[64:67], v[196:199], v[80:83]
    v_or3_b32 v10, v10, v205, v206
    v_bitop3_b32 v10, v10, v207, s44 bitop3:0xa8
    v_mfma_f32_16x16x32_bf16 v[84:87], a[68:71], v[196:199], v[84:87]
    buffer_load_dwordx4 v[148:151], v3, s[32:35], s4 offen offset:2048 sc1
    v_mfma_f32_16x16x32_bf16 v[88:91], a[72:75], v[196:199], v[88:91]
    s_add_u32 s4, s47, 16384
    v_cmp_ne_u32 vcc, 0, v10
    v_mfma_f32_16x16x32_bf16 v[92:95], a[76:79], v[196:199], v[92:95]
    s_cbranch_vccnz fnet_kernel_nx15
fnet_kernel_go16:
    v_mfma_f32_16x16x32_bf16 v[96:99], a[64:67], v[200:203], v[96:99]
    s_waitcnt vmcnt(12)
    v_lshl_add_u64 v[208:209], v[208:209], 0, v[62:63]
    v_lshl_add_u64 v[210:211], v[210:211], 0, v[62:63]
    v_mfma_f32_16x16x32_bf16 v[100:103], a[68:71], v[200:203], v[100:103]
    buffer_load_dwordx4 v[152:155], v3, s[32:35], s4 offen offset:0 sc1
    v_mfma_f32_16x16x32_bf16 v[104:107], a[72:75], v[200:203], v[104:107]
    v_lshl_add_u64 v[212:213], v[212:213], 0, v[62:63]
    v_or3_b32 v10, v208, v209, v210
    v_mfma_f32_16x16x32_bf16 v[108:111], a[76:79], v[200:203], v[108:111]
    v_lshl_add_u64 v[214:215], v[214:215], 0, v[62:63]
    v_or3_b32 v10, v10, v211, v212
    v_mfma_f32_16x16x32_bf16 v[128:131], a[64:67], v[204:207], v[128:131]
    v_or3_b32 v10, v10, v213, v214
    v_bitop3_b32 v10, v10, v215, s44 bitop3:0xa8
    v_mfma_f32_16x16x32_bf16 v[132:135], a[68:71], v[204:207], v[132:135]
    v_cmp_ne_u32 vcc, 0, v10
    v_mfma_f32_16x16x32_bf16 v[136:139], a[72:75], v[204:207], v[136:139]
    v_mfma_f32_16x16x32_bf16 v[140:143], a[76:79], v[204:207], v[140:143]
    s_cbranch_vccnz fnet_kernel_nx17
fnet_kernel_go18:
    v_mfma_f32_16x16x32_bf16 v[64:67], a[80:83], v[208:211], v[64:67]
    s_waitcnt vmcnt(11)
    buffer_load_dwordx4 v[156:159], v3, s[32:35], s4 offen offset:2048 sc1
    v_mfma_f32_16x16x32_bf16 v[68:71], a[84:87], v[208:211], v[68:71]
    v_lshl_add_u64 v[216:217], v[216:217], 0, v[62:63]
    v_lshl_add_u64 v[218:219], v[218:219], 0, v[62:63]
    v_mfma_f32_16x16x32_bf16 v[72:75], a[88:91], v[208:211], v[72:75]
    v_lshl_add_u64 v[220:221], v[220:221], 0, v[62:63]
    v_or3_b32 v10, v216, v217, v218
    v_mfma_f32_16x16x32_bf16 v[76:79], a[92:95], v[208:211], v[76:79]
    v_mfma_f32_16x16x32_bf16 v[80:83], a[80:83], v[212:215], v[80:83]
    buffer_load_dwordx4 v53, s[28:31], s3 offen offset:1024 lds
    v_mfma_f32_16x16x32_bf16 v[84:87], a[84:87], v[212:215], v[84:87]
    v_lshl_add_u64 v[222:223], v[222:223], 0, v[62:63]
    v_or3_b32 v10, v10, v219, v220
    v_mfma_f32_16x16x32_bf16 v[88:91], a[88:91], v[212:215], v[88:91]
    v_or3_b32 v10, v10, v221, v222
    v_bitop3_b32 v10, v10, v223, s44 bitop3:0xa8
    v_mfma_f32_16x16x32_bf16 v[92:95], a[92:95], v[212:215], v[92:95]
    v_cmp_ne_u32 vcc, 0, v10
    buffer_load_dwordx4 v54, s[28:31], s3 offen offset:2048 lds
    s_cbranch_vccnz fnet_kernel_nx19
fnet_kernel_go20:
    v_mfma_f32_16x16x32_bf16 v[96:99], a[80:83], v[216:219], v[96:99]
    s_waitcnt vmcnt(12)
    v_lshl_add_u64 v[224:225], v[224:225], 0, v[62:63]
    v_lshl_add_u64 v[226:227], v[226:227], 0, v[62:63]
    v_mfma_f32_16x16x32_bf16 v[100:103], a[84:87], v[216:219], v[100:103]
    v_lshl_add_u64 v[228:229], v[228:229], 0, v[62:63]
    v_or3_b32 v10, v224, v225, v226
    v_mfma_f32_16x16x32_bf16 v[104:107], a[88:91], v[216:219], v[104:107]
    buffer_load_dwordx4 v55, s[28:31], s3 offen offset:3072 lds
    v_mfma_f32_16x16x32_bf16 v[108:111], a[92:95], v[216:219], v[108:111]
    s_add_u32 s4, s11, 20480
    v_lshl_add_u64 v[230:231], v[230:231], 0, v[62:63]
    v_or3_b32 v10, v10, v227, v228
    v_mfma_f32_16x16x32_bf16 v[128:131], a[80:83], v[220:223], v[128:131]
    s_add_u32 m0, s14, 16384
    v_or3_b32 v10, v10, v229, v230
    v_bitop3_b32 v10, v10, v231, s44 bitop3:0xa8
    v_mfma_f32_16x16x32_bf16 v[132:135], a[84:87], v[220:223], v[132:135]
    s_add_u32 s3, s15, 294912
    v_mfma_f32_16x16x32_bf16 v[136:139], a[88:91], v[220:223], v[136:139]
    buffer_load_dwordx4 v[160:163], v3, s[32:35], s4 offen offset:0 sc1
    v_mfma_f32_16x16x32_bf16 v[140:143], a[92:95], v[220:223], v[140:143]
    v_cmp_ne_u32 vcc, 0, v10
    s_cbranch_vccnz fnet_kernel_nx21
fnet_kernel_go22:
    v_mfma_f32_16x16x32_bf16 v[64:67], a[96:99], v[224:227], v[64:67]
    s_waitcnt vmcnt(12)
    v_lshl_add_u64 v[232:233], v[232:233], 0, v[62:63]
    v_lshl_add_u64 v[234:235], v[234:235], 0, v[62:63]
    v_mfma_f32_16x16x32_bf16 v[68:71], a[100:103], v[224:227], v[68:71]
    buffer_load_dwordx4 v[164:167], v3, s[32:35], s4 offen offset:2048 sc1
    v_mfma_f32_16x16x32_bf16 v[72:75], a[104:107], v[224:227], v[72:75]
    s_add_u32 s4, s47, 20480
    v_lshl_add_u64 v[236:237], v[236:237], 0, v[62:63]
    v_or3_b32 v10, v232, v233, v234
    v_mfma_f32_16x16x32_bf16 v[76:79], a[108:111], v[224:227], v[76:79]
    v_lshl_add_u64 v[238:239], v[238:239], 0, v[62:63]
    v_or3_b32 v10, v10, v235, v236
    v_mfma_f32_16x16x32_bf16 v[80:83], a[96:99], v[228:231], v[80:83]
    v_or3_b32 v10, v10, v237, v238
    v_bitop3_b32 v10, v10, v239, s44 bitop3:0xa8
    v_mfma_f32_16x16x32_bf16 v[84:87], a[100:103], v[228:231], v[84:87]
    buffer_load_dwordx4 v[168:171], v3, s[32:35], s4 offen offset:0 sc1
    v_mfma_f32_16x16x32_bf16 v[88:91], a[104:107], v[228:231], v[88:91]
    v_cmp_ne_u32 vcc, 0, v10
    v_mfma_f32_16x16x32_bf16 v[92:95], a[108:111], v[228:231], v[92:95]
    s_cbranch_vccnz fnet_kernel_nx23
fnet_kernel_go24:
    v_mfma_f32_16x16x32_bf16 v[96:99], a[96:99], v[232:235], v[96:99]
    s_waitcnt vmcnt(12)
    v_mfma_f32_16x16x32_bf16 v[100:103], a[100:103], v[232:235], v[100:103]
    buffer_load_dwordx4 v[172:175], v3, s[32:35], s4 offen offset:2048 sc1
    v_mfma_f32_16x16x32_bf16 v[104:107], a[104:107], v[232:235], v[104:107]
    v_lshl_add_u64 v[240:241], v[240:241], 0, v[62:63]
    v_lshl_add_u64 v[242:243], v[242:243], 0, v[62:63]
    v_mfma_f32_16x16x32_bf16 v[108:111], a[108:111], v[232:235], v[108:111]
    v_lshl_add_u64 v[244:245], v[244:245], 0, v[62:63]
    v_or3_b32 v10, v240, v241, v242
    v_mfma_f32_16x16x32_bf16 v[128:131], a[96:99], v[236:239], v[128:131]
    v_mfma_f32_16x16x32_bf16 v[132:135], a[100:103], v[236:239], v[132:135]
    buffer_load_dwordx4 v52, s[28:31], s3 offen offset:0 lds
    v_mfma_f32_16x16x32_bf16 v[136:139], a[104:107], v[236:239], v[136:139]
    v_lshl_add_u64 v[246:247], v[246:247], 0, v[62:63]
    v_or3_b32 v10, v10, v243, v244
    v_mfma_f32_16x16x32_bf16 v[140:143], a[108:111], v[236:239], v[140:143]
    v_or3_b32 v10, v10, v245, v246
    v_bitop3_b32 v10, v10, v247, s44 bitop3:0xa8
    v_cmp_ne_u32 vcc, 0, v10
    buffer_load_dwordx4 v53, s[28:31], s3 offen offset:1024 lds
    s_cbranch_vccnz fnet_kernel_nx25
fnet_kernel_go26:
    v_mfma_f32_16x16x32_bf16 v[64:67], a[112:115], v[240:243], v[64:67]
    s_waitcnt vmcnt(13)
    v_lshl_add_u64 v[248:249], v[248:249], 0, v[62:63]
    v_lshl_add_u64 v[250:251], v[250:251], 0, v[62:63]
    v_mfma_f32_16x16x32_bf16 v[68:71], a[116:119], v[240:243], v[68:71]
    v_lshl_add_u64 v[252:253], v[252:253], 0, v[62:63]
    v_or3_b32 v10, v248, v249, v250
    v_mfma_f32_16x16x32_bf16 v[72:75], a[120:123], v[240:243], v[72:75]
    v_mfma_f32_16x16x32_bf16 v[76:79], a[124:127], v[240:243], v[76:79]
    buffer_load_dwordx4 v54, s[28:31], s3 offen offset:2048 lds
    v_mfma_f32_16x16x32_bf16 v[80:83], a[112:115], v[244:247], v[80:83]
    v_lshl_add_u64 v[254:255], v[254:255], 0, v[62:63]
    v_or3_b32 v10, v10, v251, v252
    v_mfma_f32_16x16x32_bf16 v[84:87], a[116:119], v[244:247], v[84:87]
    v_or3_b32 v10, v10, v253, v254
    v_bitop3_b32 v10, v10, v255, s44 bitop3:0xa8
    v_mfma_f32_16x16x32_bf16 v[88:91], a[120:123], v[244:247], v[88:91]
    buffer_load_dwordx4 v55, s[28:31], s3 offen offset:3072 lds
    v_mfma_f32_16x16x32_bf16 v[92:95], a[124:127], v[244:247], v[92:95]
    s_add_u32 s4, s11, 24576
    v_cmp_ne_u32 vcc, 0, v10
    s_cbranch_vccnz fnet_kernel_nx27
fnet_kernel_go28:
    v_mfma_f32_16x16x32_bf16 v[96:99], a[112:115], v[248:251], v[96:99]
    s_waitcnt vmcnt(13)
    v_lshl_add_u64 v[144:145], v[144:145], 0, v[62:63]
    v_lshl_add_u64 v[12:13], v[146:147], 0, v[62:63]
    v_mfma_f32_16x16x32_bf16 v[100:103], a[116:119], v[248:251], v[100:103]
    v_lshl_add_u64 v[146:147], v[148:149], 0, v[62:63]
    v_or3_b32 v10, v144, v145, v12
    v_mfma_f32_16x16x32_bf16 v[104:107], a[120:123], v[248:251], v[104:107]
    v_lshl_add_u64 v[150:151], v[150:151], 0, v[62:63]
    v_or3_b32 v10, v10, v13, v146
    v_mfma_f32_16x16x32_bf16 v[108:111], a[124:127], v[248:251], v[108:111]
    v_or3_b32 v10, v10, v147, v150
    v_bitop3_b32 v10, v10, v151, s44 bitop3:0xa8
    v_mfma_f32_16x16x32_bf16 v[128:131], a[112:115], v[252:255], v[128:131]
    v_mfma_f32_16x16x32_bf16 v[132:135], a[116:119], v[252:255], v[132:135]
    buffer_load_dwordx4 v[176:179], v3, s[32:35], s4 offen offset:0 sc1
    v_mfma_f32_16x16x32_bf16 v[136:139], a[120:123], v[252:255], v[136:139]
    v_cmp_ne_u32 vcc, 0, v10
    v_mov_b64 v[148:149], v[12:13]
    v_mfma_f32_16x16x32_bf16 v[140:143], a[124:127], v[252:255], v[140:143]
    s_cbranch_vccnz fnet_kernel_nx29
fnet_kernel_go30:
    v_mfma_f32_16x16x32_bf16 v[64:67], a[128:131], v[144:147], v[64:67]
    s_waitcnt vmcnt(12)
    v_mfma_f32_16x16x32_bf16 v[68:71], a[132:135], v[144:147], v[68:71]
    buffer_load_dwordx4 v[180:183], v3, s[32:35], s4 offen offset:2048 sc1
    v_mfma_f32_16x16x32_bf16 v[72:75], a[136:139], v[144:147], v[72:75]
    s_add_u32 s4, s47, 24576
    v_lshl_add_u64 v[152:153], v[152:153], 0, v[62:63]
    v_lshl_add_u64 v[12:13], v[154:155], 0, v[62:63]
    v_mfma_f32_16x16x32_bf16 v[76:79], a[140:143], v[144:147], v[76:79]
    v_lshl_add_u64 v[154:155], v[156:157], 0, v[62:63]
    v_or3_b32 v10, v152, v153, v12
    v_mfma_f32_16x16x32_bf16 v[80:83], a[128:131], v[148:151], v[80:83]
    buffer_load_dwordx4 v[184:187], v3, s[32:35], s4 offen offset:0 sc1
    v_mfma_f32_16x16x32_bf16 v[84:87], a[132:135], v[148:151], v[84:87]
    v_lshl_add_u64 v[158:159], v[158:159], 0, v[62:63]
    v_or3_b32 v10, v10, v13, v154
    v_mfma_f32_16x16x32_bf16 v[88:91], a[136:139], v[148:151], v[88:91]
    v_or3_b32 v10, v10, v155, v158
    v_bitop3_b32 v10, v10, v159, s44 bitop3:0xa8
    v_mfma_f32_16x16x32_bf16 v[92:95], a[140:143], v[148:151], v[92:95]
    v_cmp_ne_u32 vcc, 0, v10
    v_mov_b64 v[156:157], v[12:13]
    buffer_load_dwordx4 v[188:191], v3, s[32:35], s4 offen offset:2048 sc1
    s_cbranch_vccnz fnet_kernel_nx31
fnet_kernel_go32:
    v_mfma_f32_16x16x32_bf16 v[96:99], a[128:131], v[152:155], v[96:99]
    s_add_u32 s4, s11, 45056
    s_waitcnt vmcnt(10)
    v_mfma_f32_16x16x32_bf16 v[100:103], a[132:135], v[152:155], v[100:103]
    ds_read_b64_tr_b16 a[192:193], v56 offset:12288
    buffer_load_dwordx4 v[192:195], v3, s[32:35], s4 offen offset:0 sc1
    v_mfma_f32_16x16x32_bf16 v[104:107], a[136:139], v[152:155], v[104:107]
    ds_read_b64_tr_b16 a[196:197], v57 offset:12288
    ds_read_b64_tr_b16 a[200:201], v58 offset:12288
    v_mfma_f32_16x16x32_bf16 v[108:111], a[140:143], v[152:155], v[108:111]
    ds_read_b64_tr_b16 a[204:205], v59 offset:12288
    buffer_load_dwordx4 v[196:199], v3, s[32:35], s4 offen offset:2048 sc1
    v_mfma_f32_16x16x32_bf16 v[128:131], a[128:131], v[156:159], v[128:131]
    s_add_u32 s4, s11, 49152
    ds_read_b64_tr_b16 a[194:195], v56 offset:14336
    ds_read_b64_tr_b16 a[198:199], v57 offset:14336
    v_mfma_f32_16x16x32_bf16 v[132:135], a[132:135], v[156:159], v[132:135]
    ds_read_b64_tr_b16 a[202:203], v58 offset:14336
    buffer_load_dwordx4 v[208:211], v3, s[32:35], s4 offen offset:0 sc1
    v_mfma_f32_16x16x32_bf16 v[136:139], a[136:139], v[156:159], v[136:139]
    ds_read_b64_tr_b16 a[206:207], v59 offset:14336
    v_lshl_add_u64 v[160:161], v[160:161], 0, v[62:63]
    v_mfma_f32_16x16x32_bf16 v[140:143], a[140:143], v[156:159], v[140:143]
    v_lshl_add_u64 v[12:13], v[162:163], 0, v[62:63]
    v_lshl_add_u64 v[162:163], v[164:165], 0, v[62:63]
    v_or3_b32 v10, v160, v161, v12
    v_lshl_add_u64 v[166:167], v[166:167], 0, v[62:63]
    v_or3_b32 v10, v10, v13, v162
    v_or3_b32 v10, v10, v163, v166
    v_bitop3_b32 v10, v10, v167, s44 bitop3:0xa8
    v_cmp_ne_u32 vcc, 0, v10
    v_mov_b64 v[164:165], v[12:13]
    buffer_load_dwordx4 v[212:215], v3, s[32:35], s4 offen offset:2048 sc1
    s_cbranch_vccnz fnet_kernel_nx33
fnet_kernel_go34:
    v_mfma_f32_16x16x32_bf16 v[64:67], a[144:147], v[160:163], v[64:67]
    s_add_u32 s4, s11, 53248
    s_waitcnt vmcnt(12)
    v_mfma_f32_16x16x32_bf16 v[68:71], a[148:151], v[160:163], v[68:71]
    buffer_load_dwordx4 v[224:227], v3, s[32:35], s4 offen offset:0 sc1
    v_mfma_f32_16x16x32_bf16 v[72:75], a[152:155], v[160:163], v[72:75]
    v_lshl_add_u64 v[168:169], v[168:169], 0, v[62:63]
    v_lshl_add_u64 v[12:13], v[170:171], 0, v[62:63]
    v_mfma_f32_16x16x32_bf16 v[76:79], a[156:159], v[160:163], v[76:79]
    v_lshl_add_u64 v[170:171], v[172:173], 0, v[62:63]
    v_or3_b32 v10, v168, v169, v12
    v_mfma_f32_16x16x32_bf16 v[80:83], a[144:147], v[164:167], v[80:83]
    buffer_load_dwordx4 v[228:231], v3, s[32:35], s4 offen offset:2048 sc1
    v_mfma_f32_16x16x32_bf16 v[84:87], a[148:151], v[164:167], v[84:87]
    s_add_u32 s4, s47, 45056
    v_lshl_add_u64 v[174:175], v[174:175], 0, v[62:63]
    v_or3_b32 v10, v10, v13, v170
    v_mfma_f32_16x16x32_bf16 v[88:91], a[152:155], v[164:167], v[88:91]
    v_or3_b32 v10, v10, v171, v174
    v_bitop3_b32 v10, v10, v175, s44 bitop3:0xa8
    v_mfma_f32_16x16x32_bf16 v[92:95], a[156:159], v[164:167], v[92:95]
    v_cmp_ne_u32 vcc, 0, v10
    v_mov_b64 v[172:173], v[12:13]
    buffer_load_dwordx4 v[200:203], v3, s[32:35], s4 offen offset:0 sc1
    s_cbranch_vccnz fnet_kernel_nx35
fnet_kernel_go36:
    v_mfma_f32_16x16x32_bf16 v[96:99], a[144:147], v[168:171], v[96:99]
    v_mfma_f32_16x16x32_bf16 v[100:103], a[148:151], v[168:171], v[100:103]
    v_mfma_f32_16x16x32_bf16 v[104:107], a[152:155], v[168:171], v[104:107]
    v_mfma_f32_16x16x32_bf16 v[108:111], a[156:159], v[168:171], v[108:111]
    buffer_load_dwordx4 v[204:207], v3, s[32:35], s4 offen offset:2048 sc1
    v_mfma_f32_16x16x32_bf16 v[128:131], a[144:147], v[172:175], v[128:131]
    s_add_u32 s4, s47, 49152
    v_mfma_f32_16x16x32_bf16 v[132:135], a[148:151], v[172:175], v[132:135]
    v_mfma_f32_16x16x32_bf16 v[136:139], a[152:155], v[172:175], v[136:139]
    s_waitcnt vmcnt(12)
    ds_read_b64_tr_b16 a[208:209], v56 offset:16384
    ds_read_b64_tr_b16 a[212:213], v57 offset:16384
    v_mfma_f32_16x16x32_bf16 v[140:143], a[156:159], v[172:175], v[140:143]
    s_waitcnt lgkmcnt(2)
    s_waitcnt vmcnt(10)
    v_lshl_add_u64 v[176:177], v[176:177], 0, v[62:63]
    v_lshl_add_u64 v[12:13], v[178:179], 0, v[62:63]
    v_lshl_add_u64 v[178:179], v[180:181], 0, v[62:63]
    v_or3_b32 v10, v176, v177, v12
    v_lshl_add_u64 v[182:183], v[182:183], 0, v[62:63]
    v_or3_b32 v10, v10, v13, v178
    ds_read_b64_tr_b16 a[216:217], v58 offset:16384
    ds_read_b64_tr_b16 a[220:221], v59 offset:16384
    ds_read_b64_tr_b16 a[210:211], v56 offset:18432
    buffer_load_dwordx4 v[216:219], v3, s[32:35], s4 offen offset:0 sc1
    v_or3_b32 v10, v10, v179, v182
    v_bitop3_b32 v10, v10, v183, s44 bitop3:0xa8
    v_cmp_ne_u32 vcc, 0, v10
    v_mov_b64 v[180:181], v[12:13]
    ds_read_b64_tr_b16 a[214:215], v57 offset:18432
    buffer_load_dwordx4 v[220:223], v3, s[32:35], s4 offen offset:2048 sc1
    s_cbranch_vccnz fnet_kernel_nx37
fnet_kernel_go38:
    v_mfma_f32_16x16x32_bf16 v[64:67], a[160:163], v[176:179], v[64:67]
    s_add_u32 s4, s47, 53248
    ds_read_b64_tr_b16 a[218:219], v58 offset:18432
    ds_read_b64_tr_b16 a[222:223], v59 offset:18432
    v_mfma_f32_16x16x32_bf16 v[68:71], a[164:167], v[176:179], v[68:71]
    s_waitcnt vmcnt(10)
    v_mfma_f32_16x16x32_bf16 v[72:75], a[168:171], v[176:179], v[72:75]
    buffer_load_dwordx4 v[232:235], v3, s[32:35], s4 offen offset:0 sc1
    v_mfma_f32_16x16x32_bf16 v[76:79], a[172:175], v[176:179], v[76:79]
    v_lshl_add_u64 v[184:185], v[184:185], 0, v[62:63]
    v_lshl_add_u64 v[12:13], v[186:187], 0, v[62:63]
    v_mfma_f32_16x16x32_bf16 v[80:83], a[160:163], v[180:183], v[80:83]
    buffer_load_dwordx4 v[236:239], v3, s[32:35], s4 offen offset:2048 sc1
    v_mfma_f32_16x16x32_bf16 v[84:87], a[164:167], v[180:183], v[84:87]
    v_lshl_add_u64 v[186:187], v[188:189], 0, v[62:63]
    v_or3_b32 v10, v184, v185, v12
    v_mfma_f32_16x16x32_bf16 v[88:91], a[168:171], v[180:183], v[88:91]
    v_lshl_add_u64 v[190:191], v[190:191], 0, v[62:63]
    v_or3_b32 v10, v10, v13, v186
    v_mfma_f32_16x16x32_bf16 v[92:95], a[172:175], v[180:183], v[92:95]
    v_or3_b32 v10, v10, v187, v190
    v_bitop3_b32 v10, v10, v191, s44 bitop3:0xa8
    v_cmp_ne_u32 vcc, 0, v10
    v_mov_b64 v[188:189], v[12:13]
    s_cbranch_vccnz fnet_kernel_nx39
fnet_kernel_go40:
    v_mfma_f32_16x16x32_bf16 v[96:99], a[160:163], v[184:187], v[96:99]
    s_waitcnt vmcnt(10)
    v_mfma_f32_16x16x32_bf16 v[100:103], a[164:167], v[184:187], v[100:103]
    v_lshl_add_u64 v[192:193], v[192:193], 0, v[62:63]
    v_lshl_add_u64 v[12:13], v[194:195], 0, v[62:63]
    v_mfma_f32_16x16x32_bf16 v[104:107], a[168:171], v[184:187], v[104:107]
    v_lshl_add_u64 v[194:195], v[196:197], 0, v[62:63]
    v_or3_b32 v10, v192, v193, v12
    v_mfma_f32_16x16x32_bf16 v[108:111], a[172:175], v[184:187], v[108:111]
    v_lshl_add_u64 v[198:199], v[198:199], 0, v[62:63]
    v_or3_b32 v10, v10, v13, v194
    v_mfma_f32_16x16x32_bf16 v[128:131], a[160:163], v[188:191], v[128:131]
    v_or3_b32 v10, v10, v195, v198
    v_bitop3_b32 v10, v10, v199, s44 bitop3:0xa8
    v_mfma_f32_16x16x32_bf16 v[132:135], a[164:167], v[188:191], v[132:135]
    v_cmp_ne_u32 vcc, 0, v10
    v_mov_b64 v[196:197], v[12:13]
    v_mfma_f32_16x16x32_bf16 v[136:139], a[168:171], v[188:191], v[136:139]
    v_mfma_f32_16x16x32_bf16 v[140:143], a[172:175], v[188:191], v[140:143]
    s_cbranch_vccnz fnet_kernel_nx41
fnet_kernel_go42:
    s_waitcnt vmcnt(8)
    v_mfma_f32_16x16x32_bf16 v[64:67], a[176:179], v[192:195], v[64:67]
    v_lshl_add_u64 v[208:209], v[208:209], 0, v[62:63]
    v_lshl_add_u64 v[12:13], v[210:211], 0, v[62:63]
    v_mfma_f32_16x16x32_bf16 v[68:71], a[180:183], v[192:195], v[68:71]
    v_lshl_add_u64 v[210:211], v[212:213], 0, v[62:63]
    v_or3_b32 v10, v208, v209, v12
    v_mfma_f32_16x16x32_bf16 v[72:75], a[184:187], v[192:195], v[72:75]
    v_lshl_add_u64 v[214:215], v[214:215], 0, v[62:63]
    v_or3_b32 v10, v10, v13, v210
    v_mfma_f32_16x16x32_bf16 v[76:79], a[188:191], v[192:195], v[76:79]
    v_or3_b32 v10, v10, v211, v214
    v_bitop3_b32 v10, v10, v215, s44 bitop3:0xa8
    v_cmp_ne_u32 vcc, 0, v10
    v_mov_b64 v[212:213], v[12:13]
    s_cbranch_vccnz fnet_kernel_nx43
fnet_kernel_go44:
    v_mfma_f32_16x16x32_bf16 v[64:67], a[192:195], v[208:211], v[64:67]
    s_waitcnt vmcnt(6)
    v_mfma_f32_16x16x32_bf16 v[68:71], a[196:199], v[208:211], v[68:71]
    v_lshl_add_u64 v[224:225], v[224:225], 0, v[62:63]
    v_lshl_add_u64 v[12:13], v[226:227], 0, v[62:63]
    v_mfma_f32_16x16x32_bf16 v[72:75], a[200:203], v[208:211], v[72:75]
    v_lshl_add_u64 v[226:227], v[228:229], 0, v[62:63]
    v_or3_b32 v10, v224, v225, v12
    v_mfma_f32_16x16x32_bf16 v[76:79], a[204:207], v[208:211], v[76:79]
    s_waitcnt lgkmcnt(0)
    v_lshl_add_u64 v[230:231], v[230:231], 0, v[62:63]
    v_or3_b32 v10, v10, v13, v226
    v_or3_b32 v10, v10, v227, v230
    v_bitop3_b32 v10, v10, v231, s44 bitop3:0xa8
    v_cmp_ne_u32 vcc, 0, v10
    v_mov_b64 v[228:229], v[12:13]
    s_cbranch_vccnz fnet_kernel_nx45
fnet_kernel_go46:
    v_mfma_f32_16x16x32_bf16 v[64:67], a[208:211], v[224:227], v[64:67]
    s_waitcnt vmcnt(4)
    v_mfma_f32_16x16x32_bf16 v[68:71], a[212:215], v[224:227], v[68:71]
    v_lshl_add_u64 v[200:201], v[200:201], 0, v[62:63]
    v_lshl_add_u64 v[12:13], v[202:203], 0, v[62:63]
    v_mfma_f32_16x16x32_bf16 v[72:75], a[216:219], v[224:227], v[72:75]
    v_lshl_add_u64 v[202:203], v[204:205], 0, v[62:63]
    v_or3_b32 v10, v200, v201, v12
    v_mfma_f32_16x16x32_bf16 v[76:79], a[220:223], v[224:227], v[76:79]
    ds_write_b128 v4, v[64:67] offset:0
    v_mfma_f32_16x16x32_bf16 v[80:83], a[176:179], v[196:199], v[80:83]
    v_lshl_add_u64 v[206:207], v[206:207], 0, v[62:63]
    v_or3_b32 v10, v10, v13, v202
    v_mfma_f32_16x16x32_bf16 v[84:87], a[180:183], v[196:199], v[84:87]
    ds_write_b128 v4, v[68:71] offset:1024
    v_mfma_f32_16x16x32_bf16 v[88:91], a[184:187], v[196:199], v[88:91]
    v_or3_b32 v10, v10, v203, v206
    v_bitop3_b32 v10, v10, v207, s44 bitop3:0xa8
    v_mfma_f32_16x16x32_bf16 v[92:95], a[188:191], v[196:199], v[92:95]
    v_cmp_ne_u32 vcc, 0, v10
    v_mov_b64 v[204:205], v[12:13]
    v_mfma_f32_16x16x32_bf16 v[80:83], a[192:195], v[212:215], v[80:83]
    ds_write_b128 v4, v[72:75] offset:2048
    v_mfma_f32_16x16x32_bf16 v[84:87], a[196:199], v[212:215], v[84:87]
    s_cbranch_vccnz fnet_kernel_nx47
fnet_kernel_go48:
    s_waitcnt vmcnt(2)
    v_mfma_f32_16x16x32_bf16 v[88:91], a[200:203], v[212:215], v[88:91]
    ds_write_b128 v4, v[76:79] offset:3072
    v_mfma_f32_16x16x32_bf16 v[92:95], a[204:207], v[212:215], v[92:95]
    v_lshl_add_u64 v[216:217], v[216:217], 0, v[62:63]
    v_lshl_add_u64 v[12:13], v[218:219], 0, v[62:63]
    v_mfma_f32_16x16x32_bf16 v[80:83], a[208:211], v[228:231], v[80:83]
    v_lshl_add_u64 v[218:219], v[220:221], 0, v[62:63]
    v_or3_b32 v10, v216, v217, v12
    v_mfma_f32_16x16x32_bf16 v[84:87], a[212:215], v[228:231], v[84:87]
    v_lshl_add_u64 v[222:223], v[222:223], 0, v[62:63]
    v_or3_b32 v10, v10, v13, v218
    v_mfma_f32_16x16x32_bf16 v[88:91], a[216:219], v[228:231], v[88:91]
    v_or3_b32 v10, v10, v219, v222
    v_bitop3_b32 v10, v10, v223, s44 bitop3:0xa8
    v_mfma_f32_16x16x32_bf16 v[92:95], a[220:223], v[228:231], v[92:95]
    ds_write_b128 v5, v[80:83] offset:16384
    v_mfma_f32_16x16x32_bf16 v[96:99], a[176:179], v[200:203], v[96:99]
    v_cmp_ne_u32 vcc, 0, v10
    v_mov_b64 v[220:221], v[12:13]
    v_mfma_f32_16x16x32_bf16 v[100:103], a[180:183], v[200:203], v[100:103]
    ds_write_b128 v5, v[84:87] offset:17408
    v_mfma_f32_16x16x32_bf16 v[104:107], a[184:187], v[200:203], v[104:107]
    s_cbranch_vccnz fnet_kernel_nx49
fnet_kernel_go50:
    s_waitcnt vmcnt(0)
    v_mfma_f32_16x16x32_bf16 v[108:111], a[188:191], v[200:203], v[108:111]
    v_lshl_add_u64 v[232:233], v[232:233], 0, v[62:63]
    v_lshl_add_u64 v[12:13], v[234:235], 0, v[62:63]
    v_mfma_f32_16x16x32_bf16 v[96:99], a[192:195], v[216:219], v[96:99]
    ds_write_b128 v5, v[88:91] offset:18432
    v_mfma_f32_16x16x32_bf16 v[100:103], a[196:199], v[216:219], v[100:103]
    v_lshl_add_u64 v[234:235], v[236:237], 0, v[62:63]
    v_or3_b32 v10, v232, v233, v12
    v_mfma_f32_16x16x32_bf16 v[104:107], a[200:203], v[216:219], v[104:107]
    v_lshl_add_u64 v[238:239], v[238:239], 0, v[62:63]
    v_or3_b32 v10, v10, v13, v234
    v_mfma_f32_16x16x32_bf16 v[108:111], a[204:207], v[216:219], v[108:111]
    v_or3_b32 v10, v10, v235, v238
    v_bitop3_b32 v10, v10, v239, s44 bitop3:0xa8
    v_cmp_ne_u32 vcc, 0, v10
    v_mov_b64 v[236:237], v[12:13]
    s_cbranch_vccnz fnet_kernel_nx51
fnet_kernel_go52:
    v_mfma_f32_16x16x32_bf16 v[96:99], a[208:211], v[232:235], v[96:99]
    ds_write_b128 v5, v[92:95] offset:19456
    v_mfma_f32_16x16x32_bf16 v[100:103], a[212:215], v[232:235], v[100:103]
    v_mfma_f32_16x16x32_bf16 v[104:107], a[216:219], v[232:235], v[104:107]
    v_mfma_f32_16x16x32_bf16 v[108:111], a[220:223], v[232:235], v[108:111]
    s_nop 3
    ds_write_b128 v6, v[96:99] offset:32768
    s_nop 0
    ds_write_b128 v6, v[100:103] offset:33792
    s_waitcnt lgkmcnt(2)
    s_barrier
    v_mfma_f32_16x16x32_bf16 v[128:131], a[176:179], v[204:207], v[128:131]
    ds_write_b128 v6, v[104:107] offset:34816
    ds_read_b128 v[64:67], v7 offset:0
    v_mfma_f32_16x16x32_bf16 v[132:135], a[180:183], v[204:207], v[132:135]
    v_mfma_f32_16x16x32_bf16 v[136:139], a[184:187], v[204:207], v[136:139]
    ds_write_b128 v6, v[108:111] offset:35840
    ds_read_b128 v[68:71], v7 offset:16384
    v_mfma_f32_16x16x32_bf16 v[140:143], a[188:191], v[204:207], v[140:143]
    v_mfma_f32_16x16x32_bf16 v[128:131], a[192:195], v[220:223], v[128:131]
    ds_read_b128 v[72:75], v7 offset:1024
    v_mfma_f32_16x16x32_bf16 v[132:135], a[196:199], v[220:223], v[132:135]
    ds_read_b128 v[76:79], v7 offset:17408
    v_mfma_f32_16x16x32_bf16 v[136:139], a[200:203], v[220:223], v[136:139]
    ds_read_b128 v[80:83], v7 offset:2048
    v_mfma_f32_16x16x32_bf16 v[140:143], a[204:207], v[220:223], v[140:143]
    ds_read_b128 v[84:87], v7 offset:18432
    v_mfma_f32_16x16x32_bf16 v[128:131], a[208:211], v[236:239], v[128:131]
    ds_read_b128 v[88:91], v7 offset:3072
    v_mfma_f32_16x16x32_bf16 v[132:135], a[212:215], v[236:239], v[132:135]
    ds_read_b128 v[92:95], v7 offset:19456
    v_mfma_f32_16x16x32_bf16 v[136:139], a[216:219], v[236:239], v[136:139]
    v_mfma_f32_16x16x32_bf16 v[140:143], a[220:223], v[236:239], v[140:143]
    s_waitcnt lgkmcnt(7)
    s_barrier
    s_waitcnt lgkmcnt(6)
    ds_read_b128 v[144:147], v7 offset:32768
    ds_read_b128 v[148:151], v7 offset:33792
    v_pk_add_f32 v[64:65], v[64:65], v[68:69]
    ds_read_b128 v[152:155], v7 offset:34816
    v_pk_add_f32 v[66:67], v[66:67], v[70:71]
    s_waitcnt lgkmcnt(7)
    ds_read_b128 v[156:159], v7 offset:35840
    v_pk_add_f32 v[72:73], v[72:73], v[76:77]
    v_pk_add_f32 v[74:75], v[74:75], v[78:79]
    s_waitcnt lgkmcnt(6)
    v_pk_add_f32 v[80:81], v[80:81], v[84:85]
    v_pk_add_f32 v[82:83], v[82:83], v[86:87]
    s_waitcnt lgkmcnt(4)
    v_pk_add_f32 v[88:89], v[88:89], v[92:93]
    v_pk_add_f32 v[90:91], v[90:91], v[94:95]
    v_pk_add_f32 v[128:129], v[128:129], v[64:65]
    v_pk_add_f32 v[130:131], v[130:131], v[66:67]
    v_pk_add_f32 v[132:133], v[132:133], v[72:73]
    v_pk_add_f32 v[134:135], v[134:135], v[74:75]
    v_pk_add_f32 v[136:137], v[136:137], v[80:81]
    v_pk_add_f32 v[138:139], v[138:139], v[82:83]
    v_pk_add_f32 v[140:141], v[140:141], v[88:89]
    v_pk_add_f32 v[142:143], v[142:143], v[90:91]
    s_waitcnt lgkmcnt(3)
    v_pk_add_f32 v[128:129], v[128:129], v[144:145]
    v_pk_add_f32 v[130:131], v[130:131], v[146:147]
    s_waitcnt lgkmcnt(2)
    v_pk_add_f32 v[132:133], v[132:133], v[148:149]
    v_pk_add_f32 v[134:135], v[134:135], v[150:151]
    v_cvt_pk_bf16_f32 v16, v128, v129
    v_cvt_pk_bf16_f32 v17, v130, v131
    v_cvt_pk_bf16_f32 v18, v132, v133
    v_cvt_pk_bf16_f32 v19, v134, v135
    s_nop 0
    v_permlane16_swap_b32 v16, v18
    v_permlane16_swap_b32 v17, v19
    global_store_dwordx4 v2, v[16:19], s[58:59] offset:0 sc1
    s_waitcnt lgkmcnt(1)
    v_pk_add_f32 v[136:137], v[136:137], v[152:153]
    v_pk_add_f32 v[138:139], v[138:139], v[154:155]
    s_waitcnt lgkmcnt(0)
    v_pk_add_f32 v[140:141], v[140:141], v[156:157]
    v_pk_add_f32 v[142:143], v[142:143], v[158:159]
    v_cvt_pk_bf16_f32 v20, v136, v137
    v_cvt_pk_bf16_f32 v21, v138, v139
    v_cvt_pk_bf16_f32 v22, v140, v141
    v_cvt_pk_bf16_f32 v23, v142, v143
    s_nop 0
    v_permlane16_swap_b32 v20, v22
    v_permlane16_swap_b32 v21, v23
    global_store_dwordx4 v2, v[20:23], s[58:59] offset:64 sc1
fnet_kernel_end:
    s_endpgm
fnet_kernel_rty57:
    s_cmp_eq_u32 s4, 0
    s_cbranch_scc1 fnet_kernel_cont61
    s_sub_u32 s4, s4, 1
    s_mov_b32 s16, m0
    s_mov_b32 s17, s3
    s_waitcnt vmcnt(0) lgkmcnt(0)
    s_add_u32 s3, s24, 0
    s_add_u32 m0, s25, 0
    s_nop 0
    buffer_load_dwordx4 v3, s[32:35], s3 offen offset:0 sc1 lds
    buffer_load_dwordx4 v3, s[32:35], s3 offen offset:1024 sc1 lds
    s_add_u32 s3, s3, 2048
    s_add_u32 m0, s26, 0
    s_nop 0
    buffer_load_dwordx4 v3, s[32:35], s3 offen offset:0 sc1 lds
    buffer_load_dwordx4 v3, s[32:35], s3 offen offset:1024 sc1 lds
    s_add_u32 s3, s24, 4096
    s_add_u32 m0, s25, 2048
    s_nop 0
    buffer_load_dwordx4 v3, s[32:35], s3 offen offset:0 sc1 lds
    buffer_load_dwordx4 v3, s[32:35], s3 offen offset:1024 sc1 lds
    s_add_u32 m0, s26, 0
    s_nop 0
    buffer_load_dwordx4 v3, s[32:35], s3 offen offset:2048 sc1 lds
    buffer_load_dwordx4 v3, s[32:35], s3 offen offset:3072 sc1 lds
    s_add_u32 s3, s27, 0
    s_add_u32 m0, s25, 4096
    s_nop 0
    buffer_load_dwordx4 v3, s[32:35], s3 offen offset:0 sc1 lds
    buffer_load_dwordx4 v3, s[32:35], s3 offen offset:1024 sc1 lds
    s_add_u32 m0, s26, 2048
    s_nop 0
    buffer_load_dwordx4 v3, s[32:35], s3 offen offset:2048 sc1 lds
    buffer_load_dwordx4 v3, s[32:35], s3 offen offset:3072 sc1 lds
    s_add_u32 s3, s27, 4096
    s_add_u32 m0, s25, 6144
    s_nop 0
    buffer_load_dwordx4 v3, s[32:35], s3 offen offset:0 sc1 lds
    buffer_load_dwordx4 v3, s[32:35], s3 offen offset:1024 sc1 lds
    s_add_u32 m0, s26, 4096
    s_nop 0
    buffer_load_dwordx4 v3, s[32:35], s3 offen offset:2048 sc1 lds
    buffer_load_dwordx4 v3, s[32:35], s3 offen offset:3072 sc1 lds
    s_waitcnt vmcnt(0)
    s_mov_b32 m0, s16
    s_mov_b32 s3, s17
    ds_read_b64_tr_b16 v[224:225], v22 offset:0
    ds_read_b64_tr_b16 v[226:227], v22 offset:256
    ds_read_b64_tr_b16 v[228:229], v22 offset:1024
    ds_read_b64_tr_b16 v[230:231], v22 offset:1280
    ds_read_b64_tr_b16 v[232:233], v23 offset:0
    ds_read_b64_tr_b16 v[234:235], v23 offset:256
    ds_read_b64_tr_b16 v[236:237], v23 offset:1024
    ds_read_b64_tr_b16 v[238:239], v23 offset:1280
    s_waitcnt lgkmcnt(0)
    v_mfma_f32_32x32x16_bf16 v[208:223], v[224:227], v[192:195], v[64:79]
    v_mfma_f32_32x32x16_bf16 v[208:223], v[228:231], v[196:199], v[208:223]
    v_mfma_f32_32x32x16_bf16 v[208:223], v[232:235], v[200:203], v[208:223]
    v_mfma_f32_32x32x16_bf16 v[208:223], v[236:239], v[204:207], v[208:223]
    v_bitop3_b32 v26, v224, v225, s41 bitop3:0x7e
    v_bitop3_b32 v27, v226, v227, s41 bitop3:0x7e
    v_bitop3_b32 v28, v228, v229, s41 bitop3:0x7e
    v_bitop3_b32 v29, v230, v231, s41 bitop3:0x7e
    v_or3_b32 v26, v26, v27, v28
    v_bitop3_b32 v27, v232, v233, s41 bitop3:0x7e
    v_bitop3_b32 v28, v234, v235, s41 bitop3:0x7e
    v_or3_b32 v26, v26, v29, v27
    v_bitop3_b32 v27, v236, v237, s41 bitop3:0x7e
    v_bitop3_b32 v29, v238, v239, s41 bitop3:0x7e
    v_or3_b32 v26, v26, v27, v28
    v_bitop3_b32 v26, v26, v29, s48 bitop3:0xa8
    v_cmp_ne_u32 vcc, 0, v26
    s_nop 15
    s_branch fnet_kernel_stg53
fnet_kernel_rty58:
    s_cmp_eq_u32 s4, 0
    s_cbranch_scc1 fnet_kernel_cont62
    s_sub_u32 s4, s4, 1
    s_mov_b32 s16, m0
    s_mov_b32 s17, s3
    s_waitcnt vmcnt(0) lgkmcnt(0)
    s_add_u32 s3, s24, 4096
    s_add_u32 m0, s25, 2048
    s_nop 0
    buffer_load_dwordx4 v3, s[32:35], s3 offen offset:0 sc1 lds
    buffer_load_dwordx4 v3, s[32:35], s3 offen offset:1024 sc1 lds
    s_add_u32 m0, s26, 0
    s_nop 0
    buffer_load_dwordx4 v3, s[32:35], s3 offen offset:2048 sc1 lds
    buffer_load_dwordx4 v3, s[32:35], s3 offen offset:3072 sc1 lds
    s_add_u32 s3, s27, 0
    s_add_u32 m0, s25, 4096
    s_nop 0
    buffer_load_dwordx4 v3, s[32:35], s3 offen offset:0 sc1 lds
    buffer_load_dwordx4 v3, s[32:35], s3 offen offset:1024 sc1 lds
    s_add_u32 m0, s26, 2048
    s_nop 0
    buffer_load_dwordx4 v3, s[32:35], s3 offen offset:2048 sc1 lds
    buffer_load_dwordx4 v3, s[32:35], s3 offen offset:3072 sc1 lds
    s_add_u32 s3, s27, 4096
    s_add_u32 m0, s25, 6144
    s_nop 0
    buffer_load_dwordx4 v3, s[32:35], s3 offen offset:0 sc1 lds
    buffer_load_dwordx4 v3, s[32:35], s3 offen offset:1024 sc1 lds
    s_add_u32 m0, s26, 4096
    s_nop 0
    buffer_load_dwordx4 v3, s[32:35], s3 offen offset:2048 sc1 lds
    buffer_load_dwordx4 v3, s[32:35], s3 offen offset:3072 sc1 lds
    s_waitcnt vmcnt(0)
    s_mov_b32 m0, s16
    s_mov_b32 s3, s17
    ds_read_b64_tr_b16 v[224:225], v22 offset:2048
    ds_read_b64_tr_b16 v[226:227], v22 offset:2304
    ds_read_b64_tr_b16 v[228:229], v22 offset:3072
    ds_read_b64_tr_b16 v[230:231], v22 offset:3328
    ds_read_b64_tr_b16 v[232:233], v23 offset:2048
    ds_read_b64_tr_b16 v[234:235], v23 offset:2304
    ds_read_b64_tr_b16 v[236:237], v23 offset:3072
    ds_read_b64_tr_b16 v[238:239], v23 offset:3328
    s_waitcnt lgkmcnt(0)
    v_mfma_f32_32x32x16_bf16 v[64:79], v[224:227], v[192:195], v[80:95]
    v_mfma_f32_32x32x16_bf16 v[64:79], v[228:231], v[196:199], v[64:79]
    v_mfma_f32_32x32x16_bf16 v[64:79], v[232:235], v[200:203], v[64:79]
    v_mfma_f32_32x32x16_bf16 v[64:79], v[236:239], v[204:207], v[64:79]
    v_bitop3_b32 v26, v224, v225, s41 bitop3:0x7e
    v_bitop3_b32 v27, v226, v227, s41 bitop3:0x7e
    v_bitop3_b32 v28, v228, v229, s41 bitop3:0x7e
    v_bitop3_b32 v29, v230, v231, s41 bitop3:0x7e
    v_or3_b32 v26, v26, v27, v28
    v_bitop3_b32 v27, v232, v233, s41 bitop3:0x7e
    v_bitop3_b32 v28, v234, v235, s41 bitop3:0x7e
    v_or3_b32 v26, v26, v29, v27
    v_bitop3_b32 v27, v236, v237, s41 bitop3:0x7e
    v_bitop3_b32 v29, v238, v239, s41 bitop3:0x7e
    v_or3_b32 v26, v26, v27, v28
    v_bitop3_b32 v26, v26, v29, s48 bitop3:0xa8
    v_cmp_ne_u32 vcc, 0, v26
    s_nop 15
    s_branch fnet_kernel_stg54
fnet_kernel_rty59:
    s_cmp_eq_u32 s4, 0
    s_cbranch_scc1 fnet_kernel_cont63
    s_sub_u32 s4, s4, 1
    s_mov_b32 s16, m0
    s_mov_b32 s17, s3
    s_waitcnt vmcnt(0) lgkmcnt(0)
    s_add_u32 s3, s27, 0
    s_add_u32 m0, s25, 4096
    s_nop 0
    buffer_load_dwordx4 v3, s[32:35], s3 offen offset:0 sc1 lds
    buffer_load_dwordx4 v3, s[32:35], s3 offen offset:1024 sc1 lds
    s_add_u32 m0, s26, 2048
    s_nop 0
    buffer_load_dwordx4 v3, s[32:35], s3 offen offset:2048 sc1 lds
    buffer_load_dwordx4 v3, s[32:35], s3 offen offset:3072 sc1 lds
    s_add_u32 s3, s27, 4096
    s_add_u32 m0, s25, 6144
    s_nop 0
    buffer_load_dwordx4 v3, s[32:35], s3 offen offset:0 sc1 lds
    buffer_load_dwordx4 v3, s[32:35], s3 offen offset:1024 sc1 lds
    s_add_u32 m0, s26, 4096
    s_nop 0
    buffer_load_dwordx4 v3, s[32:35], s3 offen offset:2048 sc1 lds
    buffer_load_dwordx4 v3, s[32:35], s3 offen offset:3072 sc1 lds
    s_waitcnt vmcnt(0)
    s_mov_b32 m0, s16
    s_mov_b32 s3, s17
    ds_read_b64_tr_b16 v[224:225], v22 offset:4096
    ds_read_b64_tr_b16 v[226:227], v22 offset:4352
    ds_read_b64_tr_b16 v[228:229], v22 offset:5120
    ds_read_b64_tr_b16 v[230:231], v22 offset:5376
    ds_read_b64_tr_b16 v[232:233], v23 offset:4096
    ds_read_b64_tr_b16 v[234:235], v23 offset:4352
    ds_read_b64_tr_b16 v[236:237], v23 offset:5120
    ds_read_b64_tr_b16 v[238:239], v23 offset:5376
    s_waitcnt lgkmcnt(0)
    v_mfma_f32_32x32x16_bf16 v[80:95], v[224:227], v[192:195], v[96:111]
    v_mfma_f32_32x32x16_bf16 v[80:95], v[228:231], v[196:199], v[80:95]
    v_mfma_f32_32x32x16_bf16 v[80:95], v[232:235], v[200:203], v[80:95]
    v_mfma_f32_32x32x16_bf16 v[80:95], v[236:239], v[204:207], v[80:95]
    v_bitop3_b32 v26, v224, v225, s41 bitop3:0x7e
    v_bitop3_b32 v27, v226, v227, s41 bitop3:0x7e
    v_bitop3_b32 v28, v228, v229, s41 bitop3:0x7e
    v_bitop3_b32 v29, v230, v231, s41 bitop3:0x7e
    v_or3_b32 v26, v26, v27, v28
    v_bitop3_b32 v27, v232, v233, s41 bitop3:0x7e
    v_bitop3_b32 v28, v234, v235, s41 bitop3:0x7e
    v_or3_b32 v26, v26, v29, v27
    v_bitop3_b32 v27, v236, v237, s41 bitop3:0x7e
    v_bitop3_b32 v29, v238, v239, s41 bitop3:0x7e
    v_or3_b32 v26, v26, v27, v28
    v_bitop3_b32 v26, v26, v29, s48 bitop3:0xa8
    v_cmp_ne_u32 vcc, 0, v26
    s_nop 15
    s_branch fnet_kernel_stg55
fnet_kernel_rty60:
    s_cmp_eq_u32 s4, 0
    s_cbranch_scc1 fnet_kernel_cont64
    s_sub_u32 s4, s4, 1
    s_mov_b32 s16, m0
    s_mov_b32 s17, s3
    s_waitcnt vmcnt(0) lgkmcnt(0)
    s_add_u32 s3, s27, 4096
    s_add_u32 m0, s25, 6144
    s_nop 0
    buffer_load_dwordx4 v3, s[32:35], s3 offen offset:0 sc1 lds
    buffer_load_dwordx4 v3, s[32:35], s3 offen offset:1024 sc1 lds
    s_add_u32 m0, s26, 4096
    s_nop 0
    buffer_load_dwordx4 v3, s[32:35], s3 offen offset:2048 sc1 lds
    buffer_load_dwordx4 v3, s[32:35], s3 offen offset:3072 sc1 lds
    s_waitcnt vmcnt(0)
    s_mov_b32 m0, s16
    s_mov_b32 s3, s17
    ds_read_b64_tr_b16 v[224:225], v22 offset:6144
    ds_read_b64_tr_b16 v[226:227], v22 offset:6400
    ds_read_b64_tr_b16 v[228:229], v22 offset:7168
    ds_read_b64_tr_b16 v[230:231], v22 offset:7424
    ds_read_b64_tr_b16 v[232:233], v23 offset:6144
    ds_read_b64_tr_b16 v[234:235], v23 offset:6400
    ds_read_b64_tr_b16 v[236:237], v23 offset:7168
    ds_read_b64_tr_b16 v[238:239], v23 offset:7424
    s_waitcnt lgkmcnt(0)
    v_mfma_f32_32x32x16_bf16 v[96:111], v[224:227], v[192:195], v[112:127]
    v_mfma_f32_32x32x16_bf16 v[96:111], v[228:231], v[196:199], v[96:111]
    v_mfma_f32_32x32x16_bf16 v[96:111], v[232:235], v[200:203], v[96:111]
    v_mfma_f32_32x32x16_bf16 v[96:111], v[236:239], v[204:207], v[96:111]
    v_bitop3_b32 v26, v224, v225, s41 bitop3:0x7e
    v_bitop3_b32 v27, v226, v227, s41 bitop3:0x7e
    v_bitop3_b32 v28, v228, v229, s41 bitop3:0x7e
    v_bitop3_b32 v29, v230, v231, s41 bitop3:0x7e
    v_or3_b32 v26, v26, v27, v28
    v_bitop3_b32 v27, v232, v233, s41 bitop3:0x7e
    v_bitop3_b32 v28, v234, v235, s41 bitop3:0x7e
    v_or3_b32 v26, v26, v29, v27
    v_bitop3_b32 v27, v236, v237, s41 bitop3:0x7e
    v_bitop3_b32 v29, v238, v239, s41 bitop3:0x7e
    v_or3_b32 v26, v26, v27, v28
    v_bitop3_b32 v26, v26, v29, s48 bitop3:0xa8
    v_cmp_ne_u32 vcc, 0, v26
    s_nop 15
    s_branch fnet_kernel_stg56
fnet_kernel_nx1:
    s_cmp_eq_u32 s45, 0
    s_cbranch_scc1 fnet_kernel_go2
    s_mov_b32 s46, 28672
    s_cmp_ge_u32 s21, 1
    s_cselect_b32 s46, 0, s46
    s_add_u32 s46, s46, s10
    buffer_load_dwordx4 v[144:147], v3, s[32:35], s46 offen offset:0 sc1
    buffer_load_dwordx4 v[148:151], v3, s[32:35], s46 offen offset:1024 sc1
    s_sub_u32 s45, s45, 1
    s_waitcnt vmcnt(0)
    v_lshl_add_u64 v[144:145], v[144:145], 0, v[62:63]
    v_lshl_add_u64 v[146:147], v[146:147], 0, v[62:63]
    v_lshl_add_u64 v[148:149], v[148:149], 0, v[62:63]
    v_or3_b32 v10, v144, v145, v146
    v_lshl_add_u64 v[150:151], v[150:151], 0, v[62:63]
    v_or3_b32 v10, v10, v147, v148
    v_or3_b32 v10, v10, v149, v150
    v_bitop3_b32 v10, v10, v151, s44 bitop3:0xa8
    v_cmp_ne_u32 vcc, 0, v10
    s_cbranch_vccnz fnet_kernel_nx1
    s_branch fnet_kernel_go2
fnet_kernel_nx3:
    s_cmp_eq_u32 s45, 0
    s_cbranch_scc1 fnet_kernel_go4
    s_mov_b32 s46, 28672
    s_cmp_ge_u32 s21, 1
    s_cselect_b32 s46, 0, s46
    s_add_u32 s46, s46, s10
    buffer_load_dwordx4 v[152:155], v3, s[32:35], s46 offen offset:2048 sc1
    buffer_load_dwordx4 v[156:159], v3, s[32:35], s46 offen offset:3072 sc1
    s_sub_u32 s45, s45, 1
    s_waitcnt vmcnt(0)
    v_lshl_add_u64 v[152:153], v[152:153], 0, v[62:63]
    v_lshl_add_u64 v[154:155], v[154:155], 0, v[62:63]
    v_lshl_add_u64 v[156:157], v[156:157], 0, v[62:63]
    v_or3_b32 v10, v152, v153, v154
    v_lshl_add_u64 v[158:159], v[158:159], 0, v[62:63]
    v_or3_b32 v10, v10, v155, v156
    v_or3_b32 v10, v10, v157, v158
    v_bitop3_b32 v10, v10, v159, s44 bitop3:0xa8
    v_cmp_ne_u32 vcc, 0, v10
    s_cbranch_vccnz fnet_kernel_nx3
    s_branch fnet_kernel_go4
fnet_kernel_nx5:
    s_cmp_eq_u32 s45, 0
    s_cbranch_scc1 fnet_kernel_go6
    s_mov_b32 s46, 57344
    s_cmp_ge_u32 s21, 2
    s_cselect_b32 s46, 28672, s46
    s_add_u32 s46, s46, s10
    buffer_load_dwordx4 v[160:163], v3, s[32:35], s46 offen offset:0 sc1
    buffer_load_dwordx4 v[164:167], v3, s[32:35], s46 offen offset:1024 sc1
    s_sub_u32 s45, s45, 1
    s_waitcnt vmcnt(0)
    v_lshl_add_u64 v[160:161], v[160:161], 0, v[62:63]
    v_lshl_add_u64 v[162:163], v[162:163], 0, v[62:63]
    v_lshl_add_u64 v[164:165], v[164:165], 0, v[62:63]
    v_or3_b32 v10, v160, v161, v162
    v_lshl_add_u64 v[166:167], v[166:167], 0, v[62:63]
    v_or3_b32 v10, v10, v163, v164
    v_or3_b32 v10, v10, v165, v166
    v_bitop3_b32 v10, v10, v167, s44 bitop3:0xa8
    v_cmp_ne_u32 vcc, 0, v10
    s_cbranch_vccnz fnet_kernel_nx5
    s_branch fnet_kernel_go6
fnet_kernel_nx7:
    s_cmp_eq_u32 s45, 0
    s_cbranch_scc1 fnet_kernel_go8
    s_mov_b32 s46, 57344
    s_cmp_ge_u32 s21, 2
    s_cselect_b32 s46, 28672, s46
    s_add_u32 s46, s46, s10
    buffer_load_dwordx4 v[168:171], v3, s[32:35], s46 offen offset:2048 sc1
    buffer_load_dwordx4 v[172:175], v3, s[32:35], s46 offen offset:3072 sc1
    s_sub_u32 s45, s45, 1
    s_waitcnt vmcnt(0)
    v_lshl_add_u64 v[168:169], v[168:169], 0, v[62:63]
    v_lshl_add_u64 v[170:171], v[170:171], 0, v[62:63]
    v_lshl_add_u64 v[172:173], v[172:173], 0, v[62:63]
    v_or3_b32 v10, v168, v169, v170
    v_lshl_add_u64 v[174:175], v[174:175], 0, v[62:63]
    v_or3_b32 v10, v10, v171, v172
    v_or3_b32 v10, v10, v173, v174
    v_bitop3_b32 v10, v10, v175, s44 bitop3:0xa8
    v_cmp_ne_u32 vcc, 0, v10
    s_cbranch_vccnz fnet_kernel_nx7
    s_branch fnet_kernel_go8
fnet_kernel_nx9:
    s_cmp_eq_u32 s45, 0
    s_cbranch_scc1 fnet_kernel_go10
    s_mov_b32 s46, 86016
    s_cmp_ge_u32 s21, 3
    s_cselect_b32 s46, 57344, s46
    s_add_u32 s46, s46, s10
    buffer_load_dwordx4 v[176:179], v3, s[32:35], s46 offen offset:0 sc1
    buffer_load_dwordx4 v[180:183], v3, s[32:35], s46 offen offset:1024 sc1
    s_sub_u32 s45, s45, 1
    s_waitcnt vmcnt(0)
    v_lshl_add_u64 v[176:177], v[176:177], 0, v[62:63]
    v_lshl_add_u64 v[178:179], v[178:179], 0, v[62:63]
    v_lshl_add_u64 v[180:181], v[180:181], 0, v[62:63]
    v_or3_b32 v10, v176, v177, v178
    v_lshl_add_u64 v[182:183], v[182:183], 0, v[62:63]
    v_or3_b32 v10, v10, v179, v180
    v_or3_b32 v10, v10, v181, v182
    v_bitop3_b32 v10, v10, v183, s44 bitop3:0xa8
    v_cmp_ne_u32 vcc, 0, v10
    s_cbranch_vccnz fnet_kernel_nx9
    s_branch fnet_kernel_go10
fnet_kernel_nx11:
    s_cmp_eq_u32 s45, 0
    s_cbranch_scc1 fnet_kernel_go12
    s_mov_b32 s46, 86016
    s_cmp_ge_u32 s21, 3
    s_cselect_b32 s46, 57344, s46
    s_add_u32 s46, s46, s10
    buffer_load_dwordx4 v[184:187], v3, s[32:35], s46 offen offset:2048 sc1
    buffer_load_dwordx4 v[188:191], v3, s[32:35], s46 offen offset:3072 sc1
    s_sub_u32 s45, s45, 1
    s_waitcnt vmcnt(0)
    v_lshl_add_u64 v[184:185], v[184:185], 0, v[62:63]
    v_lshl_add_u64 v[186:187], v[186:187], 0, v[62:63]
    v_lshl_add_u64 v[188:189], v[188:189], 0, v[62:63]
    v_or3_b32 v10, v184, v185, v186
    v_lshl_add_u64 v[190:191], v[190:191], 0, v[62:63]
    v_or3_b32 v10, v10, v187, v188
    v_or3_b32 v10, v10, v189, v190
    v_bitop3_b32 v10, v10, v191, s44 bitop3:0xa8
    v_cmp_ne_u32 vcc, 0, v10
    s_cbranch_vccnz fnet_kernel_nx11
    s_branch fnet_kernel_go12
fnet_kernel_nx13:
    s_cmp_eq_u32 s45, 0
    s_cbranch_scc1 fnet_kernel_go14
    s_mov_b32 s46, 114688
    s_cmp_ge_u32 s21, 4
    s_cselect_b32 s46, 86016, s46
    s_add_u32 s46, s46, s10
    buffer_load_dwordx4 v[192:195], v3, s[32:35], s46 offen offset:0 sc1
    buffer_load_dwordx4 v[196:199], v3, s[32:35], s46 offen offset:1024 sc1
    s_sub_u32 s45, s45, 1
    s_waitcnt vmcnt(0)
    v_lshl_add_u64 v[192:193], v[192:193], 0, v[62:63]
    v_lshl_add_u64 v[194:195], v[194:195], 0, v[62:63]
    v_lshl_add_u64 v[196:197], v[196:197], 0, v[62:63]
    v_or3_b32 v10, v192, v193, v194
    v_lshl_add_u64 v[198:199], v[198:199], 0, v[62:63]
    v_or3_b32 v10, v10, v195, v196
    v_or3_b32 v10, v10, v197, v198
    v_bitop3_b32 v10, v10, v199, s44 bitop3:0xa8
    v_cmp_ne_u32 vcc, 0, v10
    s_cbranch_vccnz fnet_kernel_nx13
    s_branch fnet_kernel_go14
fnet_kernel_nx15:
    s_cmp_eq_u32 s45, 0
    s_cbranch_scc1 fnet_kernel_go16
    s_mov_b32 s46, 114688
    s_cmp_ge_u32 s21, 4
    s_cselect_b32 s46, 86016, s46
    s_add_u32 s46, s46, s10
    buffer_load_dwordx4 v[200:203], v3, s[32:35], s46 offen offset:2048 sc1
    buffer_load_dwordx4 v[204:207], v3, s[32:35], s46 offen offset:3072 sc1
    s_sub_u32 s45, s45, 1
    s_waitcnt vmcnt(0)
    v_lshl_add_u64 v[200:201], v[200:201], 0, v[62:63]
    v_lshl_add_u64 v[202:203], v[202:203], 0, v[62:63]
    v_lshl_add_u64 v[204:205], v[204:205], 0, v[62:63]
    v_or3_b32 v10, v200, v201, v202
    v_lshl_add_u64 v[206:207], v[206:207], 0, v[62:63]
    v_or3_b32 v10, v10, v203, v204
    v_or3_b32 v10, v10, v205, v206
    v_bitop3_b32 v10, v10, v207, s44 bitop3:0xa8
    v_cmp_ne_u32 vcc, 0, v10
    s_cbranch_vccnz fnet_kernel_nx15
    s_branch fnet_kernel_go16
fnet_kernel_nx17:
    s_cmp_eq_u32 s45, 0
    s_cbranch_scc1 fnet_kernel_go18
    s_mov_b32 s46, 143360
    s_cmp_ge_u32 s21, 5
    s_cselect_b32 s46, 114688, s46
    s_add_u32 s46, s46, s10
    buffer_load_dwordx4 v[208:211], v3, s[32:35], s46 offen offset:0 sc1
    buffer_load_dwordx4 v[212:215], v3, s[32:35], s46 offen offset:1024 sc1
    s_sub_u32 s45, s45, 1
    s_waitcnt vmcnt(0)
    v_lshl_add_u64 v[208:209], v[208:209], 0, v[62:63]
    v_lshl_add_u64 v[210:211], v[210:211], 0, v[62:63]
    v_lshl_add_u64 v[212:213], v[212:213], 0, v[62:63]
    v_or3_b32 v10, v208, v209, v210
    v_lshl_add_u64 v[214:215], v[214:215], 0, v[62:63]
    v_or3_b32 v10, v10, v211, v212
    v_or3_b32 v10, v10, v213, v214
    v_bitop3_b32 v10, v10, v215, s44 bitop3:0xa8
    v_cmp_ne_u32 vcc, 0, v10
    s_cbranch_vccnz fnet_kernel_nx17
    s_branch fnet_kernel_go18
fnet_kernel_nx19:
    s_cmp_eq_u32 s45, 0
    s_cbranch_scc1 fnet_kernel_go20
    s_mov_b32 s46, 143360
    s_cmp_ge_u32 s21, 5
    s_cselect_b32 s46, 114688, s46
    s_add_u32 s46, s46, s10
    buffer_load_dwordx4 v[216:219], v3, s[32:35], s46 offen offset:2048 sc1
    buffer_load_dwordx4 v[220:223], v3, s[32:35], s46 offen offset:3072 sc1
    s_sub_u32 s45, s45, 1
    s_waitcnt vmcnt(0)
    v_lshl_add_u64 v[216:217], v[216:217], 0, v[62:63]
    v_lshl_add_u64 v[218:219], v[218:219], 0, v[62:63]
    v_lshl_add_u64 v[220:221], v[220:221], 0, v[62:63]
    v_or3_b32 v10, v216, v217, v218
    v_lshl_add_u64 v[222:223], v[222:223], 0, v[62:63]
    v_or3_b32 v10, v10, v219, v220
    v_or3_b32 v10, v10, v221, v222
    v_bitop3_b32 v10, v10, v223, s44 bitop3:0xa8
    v_cmp_ne_u32 vcc, 0, v10
    s_cbranch_vccnz fnet_kernel_nx19
    s_branch fnet_kernel_go20
fnet_kernel_nx21:
    s_cmp_eq_u32 s45, 0
    s_cbranch_scc1 fnet_kernel_go22
    s_mov_b32 s46, 172032
    s_cmp_ge_u32 s21, 6
    s_cselect_b32 s46, 143360, s46
    s_add_u32 s46, s46, s10
    buffer_load_dwordx4 v[224:227], v3, s[32:35], s46 offen offset:0 sc1
    buffer_load_dwordx4 v[228:231], v3, s[32:35], s46 offen offset:1024 sc1
    s_sub_u32 s45, s45, 1
    s_waitcnt vmcnt(0)
    v_lshl_add_u64 v[224:225], v[224:225], 0, v[62:63]
    v_lshl_add_u64 v[226:227], v[226:227], 0, v[62:63]
    v_lshl_add_u64 v[228:229], v[228:229], 0, v[62:63]
    v_or3_b32 v10, v224, v225, v226
    v_lshl_add_u64 v[230:231], v[230:231], 0, v[62:63]
    v_or3_b32 v10, v10, v227, v228
    v_or3_b32 v10, v10, v229, v230
    v_bitop3_b32 v10, v10, v231, s44 bitop3:0xa8
    v_cmp_ne_u32 vcc, 0, v10
    s_cbranch_vccnz fnet_kernel_nx21
    s_branch fnet_kernel_go22
fnet_kernel_nx23:
    s_cmp_eq_u32 s45, 0
    s_cbranch_scc1 fnet_kernel_go24
    s_mov_b32 s46, 172032
    s_cmp_ge_u32 s21, 6
    s_cselect_b32 s46, 143360, s46
    s_add_u32 s46, s46, s10
    buffer_load_dwordx4 v[232:235], v3, s[32:35], s46 offen offset:2048 sc1
    buffer_load_dwordx4 v[236:239], v3, s[32:35], s46 offen offset:3072 sc1
    s_sub_u32 s45, s45, 1
    s_waitcnt vmcnt(0)
    v_lshl_add_u64 v[232:233], v[232:233], 0, v[62:63]
    v_lshl_add_u64 v[234:235], v[234:235], 0, v[62:63]
    v_lshl_add_u64 v[236:237], v[236:237], 0, v[62:63]
    v_or3_b32 v10, v232, v233, v234
    v_lshl_add_u64 v[238:239], v[238:239], 0, v[62:63]
    v_or3_b32 v10, v10, v235, v236
    v_or3_b32 v10, v10, v237, v238
    v_bitop3_b32 v10, v10, v239, s44 bitop3:0xa8
    v_cmp_ne_u32 vcc, 0, v10
    s_cbranch_vccnz fnet_kernel_nx23
    s_branch fnet_kernel_go24
fnet_kernel_nx25:
    s_cmp_eq_u32 s45, 0
    s_cbranch_scc1 fnet_kernel_go26
    s_mov_b32 s46, 200704
    s_cmp_ge_u32 s21, 7
    s_cselect_b32 s46, 172032, s46
    s_add_u32 s46, s46, s10
    buffer_load_dwordx4 v[240:243], v3, s[32:35], s46 offen offset:0 sc1
    buffer_load_dwordx4 v[244:247], v3, s[32:35], s46 offen offset:1024 sc1
    s_sub_u32 s45, s45, 1
    s_waitcnt vmcnt(0)
    v_lshl_add_u64 v[240:241], v[240:241], 0, v[62:63]
    v_lshl_add_u64 v[242:243], v[242:243], 0, v[62:63]
    v_lshl_add_u64 v[244:245], v[244:245], 0, v[62:63]
    v_or3_b32 v10, v240, v241, v242
    v_lshl_add_u64 v[246:247], v[246:247], 0, v[62:63]
    v_or3_b32 v10, v10, v243, v244
    v_or3_b32 v10, v10, v245, v246
    v_bitop3_b32 v10, v10, v247, s44 bitop3:0xa8
    v_cmp_ne_u32 vcc, 0, v10
    s_cbranch_vccnz fnet_kernel_nx25
    s_branch fnet_kernel_go26
fnet_kernel_nx27:
    s_cmp_eq_u32 s45, 0
    s_cbranch_scc1 fnet_kernel_go28
    s_mov_b32 s46, 200704
    s_cmp_ge_u32 s21, 7
    s_cselect_b32 s46, 172032, s46
    s_add_u32 s46, s46, s10
    buffer_load_dwordx4 v[248:251], v3, s[32:35], s46 offen offset:2048 sc1
    buffer_load_dwordx4 v[252:255], v3, s[32:35], s46 offen offset:3072 sc1
    s_sub_u32 s45, s45, 1
    s_waitcnt vmcnt(0)
    v_lshl_add_u64 v[248:249], v[248:249], 0, v[62:63]
    v_lshl_add_u64 v[250:251], v[250:251], 0, v[62:63]
    v_lshl_add_u64 v[252:253], v[252:253], 0, v[62:63]
    v_or3_b32 v10, v248, v249, v250
    v_lshl_add_u64 v[254:255], v[254:255], 0, v[62:63]
    v_or3_b32 v10, v10, v251, v252
    v_or3_b32 v10, v10, v253, v254
    v_bitop3_b32 v10, v10, v255, s44 bitop3:0xa8
    v_cmp_ne_u32 vcc, 0, v10
    s_cbranch_vccnz fnet_kernel_nx27
    s_branch fnet_kernel_go28
fnet_kernel_nx29:
    s_cmp_eq_u32 s45, 0
    s_cbranch_scc1 fnet_kernel_go30
    s_add_u32 s46, s11, 16384
    buffer_load_dwordx4 v[144:147], v3, s[32:35], s46 offen offset:0 sc1
    buffer_load_dwordx4 v[148:151], v3, s[32:35], s46 offen offset:2048 sc1
    s_sub_u32 s45, s45, 1
    s_waitcnt vmcnt(0)
    v_lshl_add_u64 v[144:145], v[144:145], 0, v[62:63]
    v_lshl_add_u64 v[12:13], v[146:147], 0, v[62:63]
    v_lshl_add_u64 v[146:147], v[148:149], 0, v[62:63]
    v_or3_b32 v10, v144, v145, v12
    v_lshl_add_u64 v[150:151], v[150:151], 0, v[62:63]
    v_or3_b32 v10, v10, v13, v146
    v_or3_b32 v10, v10, v147, v150
    v_bitop3_b32 v10, v10, v151, s44 bitop3:0xa8
    v_cmp_ne_u32 vcc, 0, v10
    v_mov_b64 v[148:149], v[12:13]
    s_cbranch_vccnz fnet_kernel_nx29
    s_branch fnet_kernel_go30
fnet_kernel_nx31:
    s_cmp_eq_u32 s45, 0
    s_cbranch_scc1 fnet_kernel_go32
    s_add_u32 s46, s47, 16384
    buffer_load_dwordx4 v[152:155], v3, s[32:35], s46 offen offset:0 sc1
    buffer_load_dwordx4 v[156:159], v3, s[32:35], s46 offen offset:2048 sc1
    s_sub_u32 s45, s45, 1
    s_waitcnt vmcnt(0)
    v_lshl_add_u64 v[152:153], v[152:153], 0, v[62:63]
    v_lshl_add_u64 v[12:13], v[154:155], 0, v[62:63]
    v_lshl_add_u64 v[154:155], v[156:157], 0, v[62:63]
    v_or3_b32 v10, v152, v153, v12
    v_lshl_add_u64 v[158:159], v[158:159], 0, v[62:63]
    v_or3_b32 v10, v10, v13, v154
    v_or3_b32 v10, v10, v155, v158
    v_bitop3_b32 v10, v10, v159, s44 bitop3:0xa8
    v_cmp_ne_u32 vcc, 0, v10
    v_mov_b64 v[156:157], v[12:13]
    s_cbranch_vccnz fnet_kernel_nx31
    s_branch fnet_kernel_go32
fnet_kernel_nx33:
    s_cmp_eq_u32 s45, 0
    s_cbranch_scc1 fnet_kernel_go34
    s_add_u32 s46, s11, 20480
    buffer_load_dwordx4 v[160:163], v3, s[32:35], s46 offen offset:0 sc1
    buffer_load_dwordx4 v[164:167], v3, s[32:35], s46 offen offset:2048 sc1
    s_sub_u32 s45, s45, 1
    s_waitcnt vmcnt(0)
    v_lshl_add_u64 v[160:161], v[160:161], 0, v[62:63]
    v_lshl_add_u64 v[12:13], v[162:163], 0, v[62:63]
    v_lshl_add_u64 v[162:163], v[164:165], 0, v[62:63]
    v_or3_b32 v10, v160, v161, v12
    v_lshl_add_u64 v[166:167], v[166:167], 0, v[62:63]
    v_or3_b32 v10, v10, v13, v162
    v_or3_b32 v10, v10, v163, v166
    v_bitop3_b32 v10, v10, v167, s44 bitop3:0xa8
    v_cmp_ne_u32 vcc, 0, v10
    v_mov_b64 v[164:165], v[12:13]
    s_cbranch_vccnz fnet_kernel_nx33
    s_branch fnet_kernel_go34
fnet_kernel_nx35:
    s_cmp_eq_u32 s45, 0
    s_cbranch_scc1 fnet_kernel_go36
    s_add_u32 s46, s47, 20480
    buffer_load_dwordx4 v[168:171], v3, s[32:35], s46 offen offset:0 sc1
    buffer_load_dwordx4 v[172:175], v3, s[32:35], s46 offen offset:2048 sc1
    s_sub_u32 s45, s45, 1
    s_waitcnt vmcnt(0)
    v_lshl_add_u64 v[168:169], v[168:169], 0, v[62:63]
    v_lshl_add_u64 v[12:13], v[170:171], 0, v[62:63]
    v_lshl_add_u64 v[170:171], v[172:173], 0, v[62:63]
    v_or3_b32 v10, v168, v169, v12
    v_lshl_add_u64 v[174:175], v[174:175], 0, v[62:63]
    v_or3_b32 v10, v10, v13, v170
    v_or3_b32 v10, v10, v171, v174
    v_bitop3_b32 v10, v10, v175, s44 bitop3:0xa8
    v_cmp_ne_u32 vcc, 0, v10
    v_mov_b64 v[172:173], v[12:13]
    s_cbranch_vccnz fnet_kernel_nx35
    s_branch fnet_kernel_go36
fnet_kernel_nx37:
    s_cmp_eq_u32 s45, 0
    s_cbranch_scc1 fnet_kernel_go38
    s_add_u32 s46, s11, 24576
    buffer_load_dwordx4 v[176:179], v3, s[32:35], s46 offen offset:0 sc1
    buffer_load_dwordx4 v[180:183], v3, s[32:35], s46 offen offset:2048 sc1
    s_sub_u32 s45, s45, 1
    s_waitcnt vmcnt(0)
    v_lshl_add_u64 v[176:177], v[176:177], 0, v[62:63]
    v_lshl_add_u64 v[12:13], v[178:179], 0, v[62:63]
    v_lshl_add_u64 v[178:179], v[180:181], 0, v[62:63]
    v_or3_b32 v10, v176, v177, v12
    v_lshl_add_u64 v[182:183], v[182:183], 0, v[62:63]
    v_or3_b32 v10, v10, v13, v178
    v_or3_b32 v10, v10, v179, v182
    v_bitop3_b32 v10, v10, v183, s44 bitop3:0xa8
    v_cmp_ne_u32 vcc, 0, v10
    v_mov_b64 v[180:181], v[12:13]
    s_cbranch_vccnz fnet_kernel_nx37
    s_branch fnet_kernel_go38
fnet_kernel_nx39:
    s_cmp_eq_u32 s45, 0
    s_cbranch_scc1 fnet_kernel_go40
    s_add_u32 s46, s47, 24576
    buffer_load_dwordx4 v[184:187], v3, s[32:35], s46 offen offset:0 sc1
    buffer_load_dwordx4 v[188:191], v3, s[32:35], s46 offen offset:2048 sc1
    s_sub_u32 s45, s45, 1
    s_waitcnt vmcnt(0)
    v_lshl_add_u64 v[184:185], v[184:185], 0, v[62:63]
    v_lshl_add_u64 v[12:13], v[186:187], 0, v[62:63]
    v_lshl_add_u64 v[186:187], v[188:189], 0, v[62:63]
    v_or3_b32 v10, v184, v185, v12
    v_lshl_add_u64 v[190:191], v[190:191], 0, v[62:63]
    v_or3_b32 v10, v10, v13, v186
    v_or3_b32 v10, v10, v187, v190
    v_bitop3_b32 v10, v10, v191, s44 bitop3:0xa8
    v_cmp_ne_u32 vcc, 0, v10
    v_mov_b64 v[188:189], v[12:13]
    s_cbranch_vccnz fnet_kernel_nx39
    s_branch fnet_kernel_go40
fnet_kernel_nx41:
    s_cmp_eq_u32 s45, 0
    s_cbranch_scc1 fnet_kernel_go42
    s_add_u32 s46, s11, 45056
    buffer_load_dwordx4 v[192:195], v3, s[32:35], s46 offen offset:0 sc1
    buffer_load_dwordx4 v[196:199], v3, s[32:35], s46 offen offset:2048 sc1
    s_sub_u32 s45, s45, 1
    s_waitcnt vmcnt(0)
    v_lshl_add_u64 v[192:193], v[192:193], 0, v[62:63]
    v_lshl_add_u64 v[12:13], v[194:195], 0, v[62:63]
    v_lshl_add_u64 v[194:195], v[196:197], 0, v[62:63]
    v_or3_b32 v10, v192, v193, v12
    v_lshl_add_u64 v[198:199], v[198:199], 0, v[62:63]
    v_or3_b32 v10, v10, v13, v194
    v_or3_b32 v10, v10, v195, v198
    v_bitop3_b32 v10, v10, v199, s44 bitop3:0xa8
    v_cmp_ne_u32 vcc, 0, v10
    v_mov_b64 v[196:197], v[12:13]
    s_cbranch_vccnz fnet_kernel_nx41
    s_branch fnet_kernel_go42
fnet_kernel_nx43:
    s_cmp_eq_u32 s45, 0
    s_cbranch_scc1 fnet_kernel_go44
    s_add_u32 s46, s11, 49152
    buffer_load_dwordx4 v[208:211], v3, s[32:35], s46 offen offset:0 sc1
    buffer_load_dwordx4 v[212:215], v3, s[32:35], s46 offen offset:2048 sc1
    s_sub_u32 s45, s45, 1
    s_waitcnt vmcnt(0)
    v_lshl_add_u64 v[208:209], v[208:209], 0, v[62:63]
    v_lshl_add_u64 v[12:13], v[210:211], 0, v[62:63]
    v_lshl_add_u64 v[210:211], v[212:213], 0, v[62:63]
    v_or3_b32 v10, v208, v209, v12
    v_lshl_add_u64 v[214:215], v[214:215], 0, v[62:63]
    v_or3_b32 v10, v10, v13, v210
    v_or3_b32 v10, v10, v211, v214
    v_bitop3_b32 v10, v10, v215, s44 bitop3:0xa8
    v_cmp_ne_u32 vcc, 0, v10
    v_mov_b64 v[212:213], v[12:13]
    s_cbranch_vccnz fnet_kernel_nx43
    s_branch fnet_kernel_go44
fnet_kernel_nx45:
    s_cmp_eq_u32 s45, 0
    s_cbranch_scc1 fnet_kernel_go46
    s_add_u32 s46, s11, 53248
    buffer_load_dwordx4 v[224:227], v3, s[32:35], s46 offen offset:0 sc1
    buffer_load_dwordx4 v[228:231], v3, s[32:35], s46 offen offset:2048 sc1
    s_sub_u32 s45, s45, 1
    s_waitcnt vmcnt(0)
    v_lshl_add_u64 v[224:225], v[224:225], 0, v[62:63]
    v_lshl_add_u64 v[12:13], v[226:227], 0, v[62:63]
    v_lshl_add_u64 v[226:227], v[228:229], 0, v[62:63]
    v_or3_b32 v10, v224, v225, v12
    v_lshl_add_u64 v[230:231], v[230:231], 0, v[62:63]
    v_or3_b32 v10, v10, v13, v226
    v_or3_b32 v10, v10, v227, v230
    v_bitop3_b32 v10, v10, v231, s44 bitop3:0xa8
    v_cmp_ne_u32 vcc, 0, v10
    v_mov_b64 v[228:229], v[12:13]
    s_cbranch_vccnz fnet_kernel_nx45
    s_branch fnet_kernel_go46
fnet_kernel_nx47:
    s_cmp_eq_u32 s45, 0
    s_cbranch_scc1 fnet_kernel_go48
    s_add_u32 s46, s47, 45056
    buffer_load_dwordx4 v[200:203], v3, s[32:35], s46 offen offset:0 sc1
    buffer_load_dwordx4 v[204:207], v3, s[32:35], s46 offen offset:2048 sc1
    s_sub_u32 s45, s45, 1
    s_waitcnt vmcnt(0)
    v_lshl_add_u64 v[200:201], v[200:201], 0, v[62:63]
    v_lshl_add_u64 v[12:13], v[202:203], 0, v[62:63]
    v_lshl_add_u64 v[202:203], v[204:205], 0, v[62:63]
    v_or3_b32 v10, v200, v201, v12
    v_lshl_add_u64 v[206:207], v[206:207], 0, v[62:63]
    v_or3_b32 v10, v10, v13, v202
    v_or3_b32 v10, v10, v203, v206
    v_bitop3_b32 v10, v10, v207, s44 bitop3:0xa8
    v_cmp_ne_u32 vcc, 0, v10
    v_mov_b64 v[204:205], v[12:13]
    s_cbranch_vccnz fnet_kernel_nx47
    s_branch fnet_kernel_go48
fnet_kernel_nx49:
    s_cmp_eq_u32 s45, 0
    s_cbranch_scc1 fnet_kernel_go50
    s_add_u32 s46, s47, 49152
    buffer_load_dwordx4 v[216:219], v3, s[32:35], s46 offen offset:0 sc1
    buffer_load_dwordx4 v[220:223], v3, s[32:35], s46 offen offset:2048 sc1
    s_sub_u32 s45, s45, 1
    s_waitcnt vmcnt(0)
    v_lshl_add_u64 v[216:217], v[216:217], 0, v[62:63]
    v_lshl_add_u64 v[12:13], v[218:219], 0, v[62:63]
    v_lshl_add_u64 v[218:219], v[220:221], 0, v[62:63]
    v_or3_b32 v10, v216, v217, v12
    v_lshl_add_u64 v[222:223], v[222:223], 0, v[62:63]
    v_or3_b32 v10, v10, v13, v218
    v_or3_b32 v10, v10, v219, v222
    v_bitop3_b32 v10, v10, v223, s44 bitop3:0xa8
    v_cmp_ne_u32 vcc, 0, v10
    v_mov_b64 v[220:221], v[12:13]
    s_cbranch_vccnz fnet_kernel_nx49
    s_branch fnet_kernel_go50
fnet_kernel_nx51:
    s_cmp_eq_u32 s45, 0
    s_cbranch_scc1 fnet_kernel_go52
    s_add_u32 s46, s47, 53248
    buffer_load_dwordx4 v[232:235], v3, s[32:35], s46 offen offset:0 sc1
    buffer_load_dwordx4 v[236:239], v3, s[32:35], s46 offen offset:2048 sc1
    s_sub_u32 s45, s45, 1
    s_waitcnt vmcnt(0)
    v_lshl_add_u64 v[232:233], v[232:233], 0, v[62:63]
    v_lshl_add_u64 v[12:13], v[234:235], 0, v[62:63]
    v_lshl_add_u64 v[234:235], v[236:237], 0, v[62:63]
    v_or3_b32 v10, v232, v233, v12
    v_lshl_add_u64 v[238:239], v[238:239], 0, v[62:63]
    v_or3_b32 v10, v10, v13, v234
    v_or3_b32 v10, v10, v235, v238
    v_bitop3_b32 v10, v10, v239, s44 bitop3:0xa8
    v_cmp_ne_u32 vcc, 0, v10
    v_mov_b64 v[236:237], v[12:13]
    s_cbranch_vccnz fnet_kernel_nx51
    s_branch fnet_kernel_go52
code_end:
.section .rodata,"a"
.p2align 6
.amdhsa_kernel fnet_kernel
  .amdhsa_next_free_vgpr 512
  .amdhsa_next_free_sgpr 102
  .amdhsa_accum_offset 256
  .amdhsa_group_segment_fixed_size 0
  .amdhsa_kernarg_size 104
  .amdhsa_user_sgpr_count 2
  .amdhsa_user_sgpr_kernarg_segment_ptr 1
  .amdhsa_system_sgpr_workgroup_id_x 1
  .amdhsa_float_denorm_mode_32 3
.end_amdhsa_kernel
```
